```python
import torch

def _softmax(x, axis=-1):
    return torch.softmax(x, dim=axis)
def _gelu(x):
    return torch.nn.functional.gelu(x, approximate="tanh")
def _silu(x):
    return torch.nn.functional.silu(x)
def _sigmoid(x):
    return torch.sigmoid(x)
def _layernorm(x, axis=-1, eps=1e-5):
    m = x.mean(dim=axis, keepdim=True)
    v = x.var(dim=axis, keepdim=True, unbiased=False)
    return (x - m) / torch.sqrt(v + eps)
def _scatter_add(tgt, idx, src, axis=0):
    return tgt.clone().index_add_(axis, idx, src)
def _segment_sum(src, seg, n):
    out = torch.zeros((n,) + src.shape[1:], dtype=src.dtype)
    return out.index_add_(0, seg, src)
def _pad(x, pw):
    flat = tuple(v for pair in reversed(pw) for v in pair)
    return torch.nn.functional.pad(x, flat)

kernel_name = 'standalone__mixer_s_mlp__prompt'

def setup_inputs():

    _w = (lambda a: (lambda t: t.to(torch.bfloat16) if t.is_floating_point() else t)(torch.as_tensor(a)))
    B, S, D, F = 1, 2048, 512, 1792
    return {
        "x":  _w((lambda *s: torch.randn(*s, dtype=torch.bfloat16) * 0.4)(B, S, D)),
        "w1": _w((lambda *s: torch.randn(*s, dtype=torch.bfloat16) * 3.2)(D, D) * (D ** -0.5)),
        "w2": _w((lambda *s: torch.randn(*s, dtype=torch.bfloat16) * 3.2)(D, D) * (D ** -0.5)),
        "w3": _w((lambda *s: torch.randn(*s, dtype=torch.bfloat16) * 3.2)(D, F) * (D ** -0.5)),
        "w4": _w((lambda *s: torch.randn(*s, dtype=torch.bfloat16) * 0.8)(F, D) * (F ** -0.5)),
    }

def reference(x, w1, w2, w3, w4):
    B, S, D = x.shape
    h = _gelu(_layernorm(x, axis=-1) @ w1)
    c = D // 4
    g0 = _pad(h[:, :, 0*c:1*c], ((0, 0), (1, 0), (0, 0)))[:, :S, :]
    g1 = _pad(h[:, :, 1*c:2*c], ((0, 0), (0, 1), (0, 0)))[:, 1:, :]
    g2 = _pad(h[:, :, 2*c:3*c], ((0, 0), (2, 0), (0, 0)))[:, :S, :]
    g3 = _pad(h[:, :, 3*c:   ], ((0, 0), (0, 2), (0, 0)))[:, 2:, :]
    hs = torch.concatenate([g0, g1, g2, g3], axis=-1) @ w2
    x1 = x + hs
    h2 = _gelu(_layernorm(x1, axis=-1) @ w3) @ w4
    return x1 + h2
```

```asm
; @launch grid=(256,1,1) block=(256,1,1) lds=163840
.amdgcn_target "amdgcn-amd-amdhsa--gfx950"
.text
.globl standalone__mixer_s_mlp__prompt_kernel
.p2align 8
.type standalone__mixer_s_mlp__prompt_kernel,@function
standalone__mixer_s_mlp__prompt_kernel:
    s_cmp_ge_u32 s2, 256
    s_cbranch_scc1 L_end
    s_load_dwordx16 s[36:51], s[0:1], 0
    s_getpc_b64 s[68:69]
L_pc:
    v_lshrrev_b32 v2, 6, v0
    v_and_b32 v0, 63, v0
    s_bfe_u32 s70, s2, 0x20003
    s_lshl_b32 s70, s70, 13
    v_lshlrev_b32 v46, 7, v0
    v_lshl_add_u32 v46, v2, 11, v46
    v_add_u32 v46, s70, v46
    v_min_u32 v46, L_codeend-L_pc-4, v46
    s_mov_b64 exec, 0xffff
    global_load_dword v255, v46, s[68:69]
    s_mov_b64 exec, -1
    v_readfirstlane_b32 s3, v2
    s_and_b32 s65, s2, 7
    s_lshr_b32 s66, s2, 3
    s_lshr_b32 s67, s66, 4
    s_lshl_b32 s52, s65, 1
    s_add_u32 s52, s52, s67
    s_and_b32 s53, s66, 15
    s_lshr_b32 s54, s53, 3
    s_and_b32 s55, s53, 7
    s_lshr_b32 s71, s66, 3
    s_lshl_b32 s59, s71, 1
    s_add_u32 s59, s59, s55
    s_lshl_b32 s56, s52, 7
    s_lshl_b32 s65, s54, 6
    s_add_u32 s56, s56, s65
    s_lshr_b32 s65, s55, 1
    s_lshr_b32 s66, s65, 1
    s_add_u32 s66, s66, 1
    s_and_b32 s65, s65, 1
    s_cmp_eq_u32 s65, 0
    s_cselect_b32 s67, -1, 1
    s_mul_i32 s66, s66, s67
    s_lshl_b32 s65, s3, 4
    s_add_u32 s72, s65, s56
    s_add_u32 s66, s66, s72
    v_lshrrev_b32 v40, 2, v0
    v_add_u32 v40, s66, v40
    v_and_b32 v40, 0xfffff, v40
    v_lshlrev_b32 v40, 10, v40
    v_lshrrev_b32 v46, 5, v0
    v_and_b32 v41, 3, v0
    v_lshlrev_b32 v42, 1, v46
    v_xor_b32 v41, v41, v42
    v_lshl_add_u32 v40, v41, 4, v40
    v_add_u32 v192, 3072, v40
    v_add_u32 v193, 2112, v40
    v_add_u32 v194, 1024, v40
    v_add_u32 v195, 64, v40
    v_bfe_u32 v47, v0, 3, 2
    v_bfe_u32 v48, v0, 1, 2
    v_and_b32 v49, 1, v0
    v_lshrrev_b32 v50, 1, v47
    v_add_u32 v50, v42, v50
    v_xor_b32 v50, v48, v50
    v_lshlrev_b32 v50, 5, v50
    v_lshl_add_u32 v50, v49, 4, v50
    v_lshl_add_u32 v50, v47, 10, v50
    v_lshl_add_u32 v196, v46, 13, v50
    v_lshl_add_u32 v200, v46, 12, v50
    v_add_u32 v197, 15360, v196
    v_add_u32 v198, 2048, v196
    v_add_u32 v199, 17408, v196
    v_lshlrev_b32 v1, 4, v0
    s_lshl_b32 s65, s55, 7
    s_lshl_b32 s57, s3, 12
    s_lshl_b32 s67, s56, 10
    s_add_u32 s67, s67, s65
    s_lshl1_add_u32 s56, s59, s3
    s_add_u32 s73, s59, 0
    s_and_b32 s73, s73, 7
    s_lshl_b32 s73, s73, 7
    s_add_u32 s74, s59, 1
    s_and_b32 s74, s74, 7
    s_lshl_b32 s74, s74, 7
    s_add_u32 s75, s59, 2
    s_and_b32 s75, s75, 7
    s_lshl_b32 s75, s75, 7
    s_add_u32 s76, s59, 3
    s_and_b32 s76, s76, 7
    s_lshl_b32 s76, s76, 7
    s_add_u32 s77, s59, 4
    s_and_b32 s77, s77, 7
    s_lshl_b32 s77, s77, 7
    s_add_u32 s78, s59, 5
    s_and_b32 s78, s78, 7
    s_lshl_b32 s78, s78, 7
    s_add_u32 s79, s59, 6
    s_and_b32 s79, s79, 7
    s_lshl_b32 s79, s79, 7
    s_add_u32 s80, s59, 7
    s_and_b32 s80, s80, 7
    s_lshl_b32 s80, s80, 7
    s_add_u32 s81, s56, 0
    s_and_b32 s81, s81, 15
    s_lshl_b32 s81, s81, 15
    s_add_u32 s60, s56, 4
    s_and_b32 s60, s60, 15
    s_lshl_b32 s60, s60, 15
    s_add_u32 s61, s56, 8
    s_and_b32 s61, s61, 15
    s_lshl_b32 s61, s61, 15
    s_add_u32 s64, s56, 12
    s_and_b32 s64, s64, 15
    s_lshl_b32 s64, s64, 15
    v_mov_b32 v52, 0
    v_mov_b32 v53, 0
    v_mov_b32 v54, 0
    v_mov_b32 v55, 0
    s_and_b32 s66, s53, 3
    s_or_b32 s66, s66, s3
    s_lshl_b32 s58, s53, 11
    s_add_u32 s58, s58, 737280
    s_lshl_b32 s70, s52, 20
    s_mov_b32 s6, 2100224
    s_mov_b32 s7, 0x20000
    s_waitcnt lgkmcnt(0)
    s_sub_u32 s4, s36, 3072
    s_subb_u32 s5, s37, 0
    s_add_u32 s28, s50, s70
    s_addc_u32 s29, s51, 0
    s_mov_b32 s30, 1048576
    s_mov_b32 s31, 0x20000
    s_cmp_lg_u32 s66, 0
    s_cbranch_scc1 Lr_1
    s_add_u32 s32, s58, 4096
    buffer_store_dwordx4 v[52:55], v1, s[28:31], s58 offen offset:0 sc1
    buffer_store_dwordx4 v[52:55], v1, s[28:31], s58 offen offset:1024 sc1
    buffer_store_dwordx4 v[52:55], v1, s[28:31], s58 offen offset:2048 sc1
    buffer_store_dwordx4 v[52:55], v1, s[28:31], s58 offen offset:3072 sc1
    buffer_store_dwordx4 v[52:55], v1, s[28:31], s32 offen offset:0 sc1
    buffer_store_dwordx4 v[52:55], v1, s[28:31], s32 offen offset:1024 sc1
    buffer_store_dwordx4 v[52:55], v1, s[28:31], s32 offen offset:2048 sc1
    buffer_store_dwordx4 v[52:55], v1, s[28:31], s32 offen offset:3072 sc1
    s_nop 1
Lr_1:
    s_add_u32 m0, s57, 98304
    s_nop 0
    buffer_load_dwordx4 v192, s[4:7], s73 offen offset:0 lds
    buffer_load_dwordx4 v193, s[4:7], s73 offen offset:1024 lds
    s_add_u32 s8, s38, s65
    s_addc_u32 s9, s39, 0
    s_mov_b32 s10, 523392
    s_mov_b32 s11, 0x20000
    s_add_u32 m0, s57, 0
    s_nop 0
    buffer_load_dwordx4 v196, s[8:11], s81 offen offset:0 lds
    buffer_load_dwordx4 v197, s[8:11], s81 offen offset:1024 lds
    buffer_load_dwordx4 v198, s[8:11], s81 offen offset:2048 lds
    buffer_load_dwordx4 v199, s[8:11], s81 offen offset:3072 lds
    s_add_u32 m0, s57, 98304
    s_nop 0
    buffer_load_dwordx4 v194, s[4:7], s74 offen offset:2048 lds
    buffer_load_dwordx4 v195, s[4:7], s74 offen offset:3072 lds
    s_add_u32 s12, s40, s65
    s_addc_u32 s13, s41, 0
    s_mov_b32 s14, 523392
    s_mov_b32 s15, 0x20000
    s_add_u32 s24, s46, s67
    s_addc_u32 s25, s47, 0
    s_mov_b32 s26, 64640
    s_mov_b32 s27, 0x20000
    v_add_u32 v201, 7168, v200
    v_add_u32 v202, 14336, v200
    v_add_u32 v203, 21504, v200
    v_lshlrev_b32 v6, 6, v0
    v_mov_b32 v10, 1
    s_mul_i32 s67, s53, 224
    s_sub_u32 s16, s42, 3072
    s_subb_u32 s17, s43, 0
    s_add_u32 s16, s16, s67
    s_addc_u32 s17, s17, 0
    s_mov_b32 s18, 1834720
    s_mov_b32 s19, 0x20000
    s_mul_i32 s67, s3, 458752
    s_add_u32 s67, s67, s65
    s_sub_u32 s20, s44, 3072
    s_subb_u32 s21, s45, 0
    s_add_u32 s20, s20, s67
    s_addc_u32 s21, s21, 0
    s_mov_b32 s22, 460928
    s_mov_b32 s23, 0x20000
    s_lshl_b32 s67, s52, 4
    s_add_u32 s62, s48, s67
    s_addc_u32 s63, s49, 0
    v_lshl_add_u32 v60, v0, 2, s67
    v_cmp_gt_u32 vcc, 4, v0
    s_nop 1
    v_cndmask_b32 v60, -1, v60, vcc
    v_lshlrev_b32 v62, 2, v0
    v_add_u32 v62, 749568, v62
    v_cndmask_b32 v62, -1, v62, vcc
    s_add_u32 s67, s67, s53
    v_mov_b32 v19, s67
    v_lshlrev_b32 v58, 7, v0
    v_add_u32 v58, s58, v58
    s_add_u32 s42, s28, 749568
    s_addc_u32 s43, s29, 0
    s_add_u32 s67, s53, 749568
    v_mov_b32 v57, s67
    s_getreg_b32 s58, hwreg(HW_REG_XCC_ID)
    s_and_b32 s58, s58, 15
    s_or_b32 s58, s58, 0x80
    v_mov_b32 v56, s58
    s_mul_i32 s58, s58, 0x01010101
    s_mov_b32 s40, s3
    s_and_b32 s68, s52, 1
    s_lshl_b32 s68, s68, 2
    s_add_u32 s52, s68, s53
    s_mov_b32 s52, 0
    s_add_u32 s71, s71, s55
    v_mov_b32 v20, 0x3f803f80
    v_mov_b32 v21, 0x3f803f80
    v_mov_b32 v22, 0x3f803f80
    v_mov_b32 v23, 0x3f803f80
    v_and_b32 v46, 15, v0
    v_lshrrev_b32 v47, 4, v0
    v_bfe_u32 v48, v0, 3, 1
    v_lshlrev_b32 v48, 1, v48
    v_xor_b32 v47, v47, v48
    v_lshlrev_b32 v46, 6, v46
    v_lshl_add_u32 v46, v47, 4, v46
    s_add_u32 s68, s57, 98304
    v_add_u32 v63, s68, v46
    v_lshrrev_b32 v46, 3, v0
    v_and_b32 v47, 7, v0
    v_lshrrev_b32 v48, 4, v0
    v_xor_b32 v47, v47, v48
    v_add_u32 v46, s72, v46
    v_lshlrev_b32 v46, 10, v46
    v_lshl_add_u32 v11, v47, 4, v46
    s_add_u32 s65, s65, 3072
    s_lshl_b32 s68, s3, 13
    s_add_u32 s68, s68, 131072
    v_lshrrev_b32 v46, 5, v0
    v_bfe_u32 v47, v0, 3, 2
    v_bfe_u32 v48, v0, 2, 1
    v_and_b32 v49, 3, v0
    v_lshrrev_b32 v50, 1, v47
    v_xor_b32 v50, v48, v50
    v_lshlrev_b32 v50, 6, v50
    v_lshl_add_u32 v50, v49, 4, v50
    v_lshl_add_u32 v47, v46, 2, v47
    v_lshl_add_u32 v7, v47, 10, v50
    v_bfe_u32 v47, v0, 2, 2
    v_bfe_u32 v48, v0, 4, 1
    v_lshlrev_b32 v50, 9, v46
    v_lshl_add_u32 v50, v47, 7, v50
    v_lshl_add_u32 v50, v48, 5, v50
    v_lshl_add_u32 v50, v49, 3, v50
    v_add_u32 v50, s68, v50
    v_lshrrev_b32 v47, 1, v47
    v_lshl_add_u32 v8, v47, 6, v50
    v_xor_b32 v47, 1, v47
    v_lshl_add_u32 v9, v47, 6, v50
    s_and_b32 s68, s3, 1
    s_lshl_b32 s68, s68, 6
    v_xor_b32 v8, s68, v8
    v_xor_b32 v9, s68, v9
    s_lshl_b32 s68, s3, 10
    s_add_u32 s68, s68, 94208
    v_add_u32 v104, s68, v1
    v_xor_b32 v105, 1024, v104
    v_xor_b32 v106, 2048, v104
    v_xor_b32 v107, 3072, v104
    s_and_b32 s70, s53, 1
    s_lshl_b32 s68, s70, 5
    s_cmp_eq_u32 s70, 0
    s_cselect_b32 s69, 192, 0
    v_add_u32 v46, 0, v0
    v_mul_u32_u24 v47, 1171, v46
    v_lshrrev_b32 v47, 16, v47
    v_mul_u32_u24 v48, 56, v47
    v_sub_u32 v46, v46, v48
    v_lshrrev_b32 v48, 4, v46
    v_and_b32 v49, 3, v46
    v_lshlrev_b32 v48, 6, v48
    v_lshl_add_u32 v48, v49, 4, v48
    v_add_u32 v48, s68, v48
    v_bfe_u32 v49, v46, 2, 2
    v_and_b32 v50, 1, v46
    v_lshlrev_b32 v50, 4, v50
    v_add_u32 v50, s69, v50
    v_bfe_u32 v51, v46, 1, 2
    v_cmp_lt_u32 vcc, 47, v46
    s_nop 1
    v_cndmask_b32 v48, v48, v50, vcc
    v_cndmask_b32 v49, v49, v51, vcc
    v_lshl_add_u32 v47, v47, 2, v49
    v_mul_u32_u24 v47, 3584, v47
    v_add_u32 v48, 3072, v48
    v_add_u32 v12, v47, v48
    s_and_b32 s70, s53, 1
    s_lshl_b32 s68, s70, 5
    s_cmp_eq_u32 s70, 0
    s_cselect_b32 s69, 192, 0
    v_add_u32 v46, 64, v0
    v_mul_u32_u24 v47, 1171, v46
    v_lshrrev_b32 v47, 16, v47
    v_mul_u32_u24 v48, 56, v47
    v_sub_u32 v46, v46, v48
    v_lshrrev_b32 v48, 4, v46
    v_and_b32 v49, 3, v46
    v_lshlrev_b32 v48, 6, v48
    v_lshl_add_u32 v48, v49, 4, v48
    v_add_u32 v48, s68, v48
    v_bfe_u32 v49, v46, 2, 2
    v_and_b32 v50, 1, v46
    v_lshlrev_b32 v50, 4, v50
    v_add_u32 v50, s69, v50
    v_bfe_u32 v51, v46, 1, 2
    v_cmp_lt_u32 vcc, 47, v46
    s_nop 1
    v_cndmask_b32 v48, v48, v50, vcc
    v_cndmask_b32 v49, v49, v51, vcc
    v_lshl_add_u32 v47, v47, 2, v49
    v_mul_u32_u24 v47, 3584, v47
    v_add_u32 v48, 2048, v48
    v_add_u32 v13, v47, v48
    s_and_b32 s70, s53, 1
    s_lshl_b32 s68, s70, 5
    s_cmp_eq_u32 s70, 0
    s_cselect_b32 s69, 192, 0
    v_add_u32 v46, 128, v0
    v_mul_u32_u24 v47, 1171, v46
    v_lshrrev_b32 v47, 16, v47
    v_mul_u32_u24 v48, 56, v47
    v_sub_u32 v46, v46, v48
    v_lshrrev_b32 v48, 4, v46
    v_and_b32 v49, 3, v46
    v_lshlrev_b32 v48, 6, v48
    v_lshl_add_u32 v48, v49, 4, v48
    v_add_u32 v48, s68, v48
    v_bfe_u32 v49, v46, 2, 2
    v_and_b32 v50, 1, v46
    v_lshlrev_b32 v50, 4, v50
    v_add_u32 v50, s69, v50
    v_bfe_u32 v51, v46, 1, 2
    v_cmp_lt_u32 vcc, 47, v46
    s_nop 1
    v_cndmask_b32 v48, v48, v50, vcc
    v_cndmask_b32 v49, v49, v51, vcc
    v_lshl_add_u32 v47, v47, 2, v49
    v_mul_u32_u24 v47, 3584, v47
    v_add_u32 v48, 1024, v48
    v_add_u32 v14, v47, v48
    s_and_b32 s70, s53, 1
    s_lshl_b32 s68, s70, 5
    s_cmp_eq_u32 s70, 0
    s_cselect_b32 s69, 192, 0
    v_add_u32 v46, 192, v0
    v_mul_u32_u24 v47, 1171, v46
    v_lshrrev_b32 v47, 16, v47
    v_mul_u32_u24 v48, 56, v47
    v_sub_u32 v46, v46, v48
    v_lshrrev_b32 v48, 4, v46
    v_and_b32 v49, 3, v46
    v_lshlrev_b32 v48, 6, v48
    v_lshl_add_u32 v48, v49, 4, v48
    v_add_u32 v48, s68, v48
    v_bfe_u32 v49, v46, 2, 2
    v_and_b32 v50, 1, v46
    v_lshlrev_b32 v50, 4, v50
    v_add_u32 v50, s69, v50
    v_bfe_u32 v51, v46, 1, 2
    v_cmp_lt_u32 vcc, 47, v46
    s_nop 1
    v_cndmask_b32 v48, v48, v50, vcc
    v_cndmask_b32 v49, v49, v51, vcc
    v_lshl_add_u32 v47, v47, 2, v49
    v_mul_u32_u24 v47, 3584, v47
    v_add_u32 v15, v47, v48
    s_and_b32 s70, s53, 1
    s_lshl_b32 s68, s70, 5
    s_cmp_eq_u32 s70, 0
    s_cselect_b32 s69, 192, 0
    v_add_u32 v46, 256, v0
    v_mul_u32_u24 v47, 1171, v46
    v_lshrrev_b32 v47, 16, v47
    v_mul_u32_u24 v48, 56, v47
    v_sub_u32 v46, v46, v48
    v_lshrrev_b32 v48, 4, v46
    v_and_b32 v49, 3, v46
    v_lshlrev_b32 v48, 6, v48
    v_lshl_add_u32 v48, v49, 4, v48
    v_add_u32 v48, s68, v48
    v_bfe_u32 v49, v46, 2, 2
    v_and_b32 v50, 1, v46
    v_lshlrev_b32 v50, 4, v50
    v_add_u32 v50, s69, v50
    v_bfe_u32 v51, v46, 1, 2
    v_cmp_lt_u32 vcc, 47, v46
    s_nop 1
    v_cndmask_b32 v48, v48, v50, vcc
    v_cndmask_b32 v49, v49, v51, vcc
    v_lshl_add_u32 v47, v47, 2, v49
    v_mul_u32_u24 v47, 3584, v47
    v_add_u32 v48, 3072, v48
    v_add_u32 v16, v47, v48
    s_and_b32 s70, s53, 1
    s_lshl_b32 s68, s70, 5
    s_cmp_eq_u32 s70, 0
    s_cselect_b32 s69, 192, 0
    v_add_u32 v46, 320, v0
    v_mul_u32_u24 v47, 1171, v46
    v_lshrrev_b32 v47, 16, v47
    v_mul_u32_u24 v48, 56, v47
    v_sub_u32 v46, v46, v48
    v_lshrrev_b32 v48, 4, v46
    v_and_b32 v49, 3, v46
    v_lshlrev_b32 v48, 6, v48
    v_lshl_add_u32 v48, v49, 4, v48
    v_add_u32 v48, s68, v48
    v_bfe_u32 v49, v46, 2, 2
    v_and_b32 v50, 1, v46
    v_lshlrev_b32 v50, 4, v50
    v_add_u32 v50, s69, v50
    v_bfe_u32 v51, v46, 1, 2
    v_cmp_lt_u32 vcc, 47, v46
    s_nop 1
    v_cndmask_b32 v48, v48, v50, vcc
    v_cndmask_b32 v49, v49, v51, vcc
    v_lshl_add_u32 v47, v47, 2, v49
    v_mul_u32_u24 v47, 3584, v47
    v_add_u32 v48, 2048, v48
    v_add_u32 v17, v47, v48
    s_and_b32 s70, s53, 1
    s_lshl_b32 s68, s70, 5
    s_cmp_eq_u32 s70, 0
    s_cselect_b32 s69, 192, 0
    v_add_u32 v46, 384, v0
    v_mul_u32_u24 v47, 1171, v46
    v_lshrrev_b32 v47, 16, v47
    v_mul_u32_u24 v48, 56, v47
    v_sub_u32 v46, v46, v48
    v_lshrrev_b32 v48, 4, v46
    v_and_b32 v49, 3, v46
    v_lshlrev_b32 v48, 6, v48
    v_lshl_add_u32 v48, v49, 4, v48
    v_add_u32 v48, s68, v48
    v_bfe_u32 v49, v46, 2, 2
    v_and_b32 v50, 1, v46
    v_lshlrev_b32 v50, 4, v50
    v_add_u32 v50, s69, v50
    v_bfe_u32 v51, v46, 1, 2
    v_cmp_lt_u32 vcc, 47, v46
    s_nop 1
    v_cndmask_b32 v48, v48, v50, vcc
    v_cndmask_b32 v49, v49, v51, vcc
    v_lshl_add_u32 v47, v47, 2, v49
    v_mul_u32_u24 v47, 3584, v47
    v_add_u32 v48, 1024, v48
    v_add_u32 v18, v47, v48
    s_lshr_b32 s68, s2, 3
    s_mul_i32 s69, s68, 7168
    s_lshl_b32 s70, s55, 7
    s_sub_u32 s69, s69, s70
    s_add_u32 s69, s69, 3072
    v_lshlrev_b32 v112, 7, v0
    v_add_u32 v113, s69, v112
    s_lshl2_add_u32 s68, s68, s3
    s_mul_i32 s68, s68, 7168
    s_mul_i32 s70, s53, 224
    s_sub_u32 s68, s68, s70
    s_add_u32 s68, s68, 3072
    v_add_u32 v112, s68, v112
    v_cmp_gt_u32 vcc, 56, v0
    v_mov_b32 v114, 0x40000000
    s_nop 0
    v_cndmask_b32 v112, v114, v112, vcc
    v_cndmask_b32 v113, v114, v113, vcc
    s_mov_b32 s32, s48
    s_mov_b32 s33, s49
    s_mov_b32 s34, 256
    s_mov_b32 s35, 0x20000
    v_lshrrev_b32 v40, 4, v0
    v_bfe_u32 v41, v0, 2, 2
    v_and_b32 v42, 3, v0
    v_lshlrev_b32 v43, 9, v40
    v_lshl_add_u32 v43, v41, 7, v43
    v_lshl_add_u32 v43, v42, 3, v43
    v_and_b32 v40, 1, v40
    v_lshrrev_b32 v41, 1, v41
    v_lshl_add_u32 v40, v40, 1, v41
    v_xor_b32 v40, s3, v40
    v_xor_b32 v41, 0, v40
    v_lshl_add_u32 v2, v41, 5, v43
    v_xor_b32 v41, 1, v40
    v_lshl_add_u32 v3, v41, 5, v43
    v_xor_b32 v41, 2, v40
    v_lshl_add_u32 v4, v41, 5, v43
    v_xor_b32 v41, 3, v40
    v_lshl_add_u32 v5, v41, 5, v43
    s_cmp_lg_u32 s66, 0
    s_nop 1
    s_cbranch_scc1 Lr_2
    s_waitcnt vmcnt(8)
    s_mov_b64 exec, 1
    buffer_store_dword v10, v19, s[32:35], 0 offen sc1
    s_mov_b64 exec, -1
Lr_2:
    s_add_u32 m0, s57, 114688
    s_nop 0
    buffer_load_dwordx4 v192, s[4:7], s75 offen offset:0 lds
    buffer_load_dwordx4 v193, s[4:7], s75 offen offset:1024 lds
    buffer_load_dwordx4 v194, s[4:7], s76 offen offset:2048 lds
    buffer_load_dwordx4 v195, s[4:7], s76 offen offset:3072 lds
    s_add_u32 m0, s57, 16384
    s_nop 0
    buffer_load_dwordx4 v196, s[8:11], s60 offen offset:0 lds
    buffer_load_dwordx4 v197, s[8:11], s60 offen offset:1024 lds
    buffer_load_dwordx4 v198, s[8:11], s60 offen offset:2048 lds
    buffer_load_dwordx4 v199, s[8:11], s60 offen offset:3072 lds
    s_waitcnt vmcnt(8)
    ds_read_b128 v[128:131], v63 offset:0
    ds_read_b128 v[132:135], v63 offset:1024
    ds_read_b128 v[136:139], v63 offset:2048
    ds_read_b128 v[140:143], v63 offset:3072
    s_barrier
    ds_read_b64_tr_b16 a[192:193], v2 offset:0
    ds_read_b64_tr_b16 a[194:195], v2 offset:2048
    ds_read_b64_tr_b16 a[196:197], v3 offset:0
    ds_read_b64_tr_b16 a[198:199], v3 offset:2048
    ds_read_b64_tr_b16 a[200:201], v4 offset:0
    ds_read_b64_tr_b16 a[202:203], v4 offset:2048
    ds_read_b64_tr_b16 a[204:205], v5 offset:0
    ds_read_b64_tr_b16 a[206:207], v5 offset:2048
    ds_read_b64_tr_b16 a[208:209], v2 offset:4096
    ds_read_b64_tr_b16 a[210:211], v2 offset:6144
    ds_read_b64_tr_b16 a[212:213], v3 offset:4096
    ds_read_b64_tr_b16 a[214:215], v3 offset:6144
    ds_read_b64_tr_b16 a[216:217], v4 offset:4096
    ds_read_b64_tr_b16 a[218:219], v4 offset:6144
    ds_read_b64_tr_b16 a[220:221], v5 offset:4096
    ds_read_b64_tr_b16 a[222:223], v5 offset:6144
    ds_read_b64_tr_b16 a[224:225], v2 offset:8192
    ds_read_b64_tr_b16 a[226:227], v2 offset:10240
    ds_read_b64_tr_b16 a[228:229], v3 offset:8192
    ds_read_b64_tr_b16 a[230:231], v3 offset:10240
    ds_read_b64_tr_b16 a[232:233], v4 offset:8192
    ds_read_b64_tr_b16 a[234:235], v4 offset:10240
    s_waitcnt lgkmcnt(15)
    v_mfma_f32_16x16x32_bf16 v[64:67], a[192:195], v[128:131], 0
    v_mfma_f32_16x16x32_bf16 v[80:83], a[192:195], v[20:23], 0
    s_add_u32 m0, s57, 131072
    s_nop 0
    buffer_load_dwordx4 v192, s[4:7], s77 offen offset:0 lds
    ds_read_b64_tr_b16 a[236:237], v5 offset:8192
    ds_read_b64_tr_b16 a[238:239], v5 offset:10240
    v_mfma_f32_16x16x32_bf16 v[68:71], a[196:199], v[128:131], 0
    buffer_load_dwordx4 v193, s[4:7], s77 offen offset:1024 lds
    v_mfma_f32_16x16x32_bf16 v[96:99], v[20:23], v[128:131], 0
    ds_read_b64_tr_b16 a[240:241], v2 offset:12288
    ds_read_b64_tr_b16 a[242:243], v2 offset:14336
    s_waitcnt lgkmcnt(15)
    v_mfma_f32_16x16x32_bf16 v[72:75], a[200:203], v[128:131], 0
    buffer_load_dwordx4 v194, s[4:7], s78 offen offset:2048 lds
    v_mfma_f32_16x16x32_bf16 v[100:103], v[128:131], v[128:131], 0
    ds_read_b64_tr_b16 a[244:245], v3 offset:12288
    ds_read_b64_tr_b16 a[246:247], v3 offset:14336
    v_mfma_f32_16x16x32_bf16 v[76:79], a[204:207], v[128:131], 0
    buffer_load_dwordx4 v195, s[4:7], s78 offen offset:3072 lds
    ds_read_b64_tr_b16 a[248:249], v4 offset:12288
    ds_read_b64_tr_b16 a[250:251], v4 offset:14336
    s_waitcnt lgkmcnt(15)
    v_mfma_f32_16x16x32_bf16 v[64:67], a[208:211], v[132:135], v[64:67]
    v_mfma_f32_16x16x32_bf16 v[80:83], a[208:211], v[20:23], v[80:83]
    s_add_u32 m0, s57, 147456
    s_nop 0
    buffer_load_dwordx4 v192, s[4:7], s79 offen offset:0 lds
    ds_read_b64_tr_b16 a[252:253], v5 offset:12288
    ds_read_b64_tr_b16 a[254:255], v5 offset:14336
    v_mfma_f32_16x16x32_bf16 v[68:71], a[212:215], v[132:135], v[68:71]
    buffer_load_dwordx4 v193, s[4:7], s79 offen offset:1024 lds
    v_mfma_f32_16x16x32_bf16 v[96:99], v[20:23], v[132:135], v[96:99]
    s_waitcnt vmcnt(6)
    ds_read_b128 v[144:147], v63 offset:16384
    ds_read_b128 v[148:151], v63 offset:17408
    ds_read_b128 v[152:155], v63 offset:18432
    ds_read_b128 v[156:159], v63 offset:19456
    s_barrier
    ds_read_b64_tr_b16 a[192:193], v2 offset:16384
    ds_read_b64_tr_b16 a[194:195], v2 offset:18432
    s_waitcnt lgkmcnt(15)
    v_mfma_f32_16x16x32_bf16 v[72:75], a[216:219], v[132:135], v[72:75]
    buffer_load_dwordx4 v194, s[4:7], s80 offen offset:2048 lds
    v_mfma_f32_16x16x32_bf16 v[100:103], v[132:135], v[132:135], v[100:103]
    ds_read_b64_tr_b16 a[196:197], v3 offset:16384
    ds_read_b64_tr_b16 a[198:199], v3 offset:18432
    v_mfma_f32_16x16x32_bf16 v[76:79], a[220:223], v[132:135], v[76:79]
    buffer_load_dwordx4 v195, s[4:7], s80 offen offset:3072 lds
    ds_read_b64_tr_b16 a[200:201], v4 offset:16384
    ds_read_b64_tr_b16 a[202:203], v4 offset:18432
    v_mfma_f32_16x16x32_bf16 v[64:67], a[224:227], v[136:139], v[64:67]
    v_mfma_f32_16x16x32_bf16 v[80:83], a[224:227], v[20:23], v[80:83]
    s_add_u32 m0, s57, 32768
    s_nop 0
    buffer_load_dwordx4 v196, s[8:11], s61 offen offset:0 lds
    ds_read_b64_tr_b16 a[204:205], v5 offset:16384
    ds_read_b64_tr_b16 a[206:207], v5 offset:18432
    v_mfma_f32_16x16x32_bf16 v[68:71], a[228:231], v[136:139], v[68:71]
    buffer_load_dwordx4 v197, s[8:11], s61 offen offset:1024 lds
    v_mfma_f32_16x16x32_bf16 v[96:99], v[20:23], v[136:139], v[96:99]
    ds_read_b64_tr_b16 a[208:209], v2 offset:20480
    ds_read_b64_tr_b16 a[210:211], v2 offset:22528
    s_waitcnt lgkmcnt(15)
    v_mfma_f32_16x16x32_bf16 v[72:75], a[232:235], v[136:139], v[72:75]
    buffer_load_dwordx4 v198, s[8:11], s61 offen offset:2048 lds
    v_mfma_f32_16x16x32_bf16 v[100:103], v[136:139], v[136:139], v[100:103]
    ds_read_b64_tr_b16 a[212:213], v3 offset:20480
    ds_read_b64_tr_b16 a[214:215], v3 offset:22528
    v_mfma_f32_16x16x32_bf16 v[76:79], a[236:239], v[136:139], v[76:79]
    buffer_load_dwordx4 v199, s[8:11], s61 offen offset:3072 lds
    ds_read_b64_tr_b16 a[216:217], v4 offset:20480
    ds_read_b64_tr_b16 a[218:219], v4 offset:22528
    v_mfma_f32_16x16x32_bf16 v[64:67], a[240:243], v[140:143], v[64:67]
    v_mfma_f32_16x16x32_bf16 v[80:83], a[240:243], v[20:23], v[80:83]
    s_add_u32 m0, s57, 49152
    s_nop 0
    buffer_load_dwordx4 v196, s[8:11], s64 offen offset:0 lds
    ds_read_b64_tr_b16 a[220:221], v5 offset:20480
    ds_read_b64_tr_b16 a[222:223], v5 offset:22528
    v_mfma_f32_16x16x32_bf16 v[68:71], a[244:247], v[140:143], v[68:71]
    buffer_load_dwordx4 v197, s[8:11], s64 offen offset:1024 lds
    v_mfma_f32_16x16x32_bf16 v[96:99], v[20:23], v[140:143], v[96:99]
    ds_read_b64_tr_b16 a[224:225], v2 offset:24576
    ds_read_b64_tr_b16 a[226:227], v2 offset:26624
    s_waitcnt lgkmcnt(15)
    v_mfma_f32_16x16x32_bf16 v[72:75], a[248:251], v[140:143], v[72:75]
    buffer_load_dwordx4 v198, s[8:11], s64 offen offset:2048 lds
    s_cmp_lg_u32 s40, 0
    s_nop 5
    s_cbranch_scc1 Lgo_3
    buffer_load_dword v59, v60, s[32:35], 0 offen sc0
Lgo_3:
    v_mfma_f32_16x16x32_bf16 v[100:103], v[140:143], v[140:143], v[100:103]
    ds_read_b64_tr_b16 a[228:229], v3 offset:24576
    ds_read_b64_tr_b16 a[230:231], v3 offset:26624
    v_mfma_f32_16x16x32_bf16 v[76:79], a[252:255], v[140:143], v[76:79]
    buffer_load_dwordx4 v199, s[8:11], s64 offen offset:3072 lds
    ds_read_b64_tr_b16 a[232:233], v4 offset:24576
    ds_read_b64_tr_b16 a[234:235], v4 offset:26624
    s_waitcnt lgkmcnt(15)
    v_mfma_f32_16x16x32_bf16 v[64:67], a[192:195], v[144:147], v[64:67]
    v_mfma_f32_16x16x32_bf16 v[80:83], a[192:195], v[20:23], v[80:83]
    s_lshr_b32 s69, s57, 1
    s_add_u32 m0, s69, 86016
    s_nop 0
    buffer_load_dwordx4 v11, s[4:7], s65 offen lds
    v_xor_b32 v11, 64, v11
    s_add_u32 s65, s65, 7168
    buffer_load_dwordx4 v11, s[4:7], s65 offen offset:1024 lds
    ds_read_b64_tr_b16 a[236:237], v5 offset:24576
    ds_read_b64_tr_b16 a[238:239], v5 offset:26624
    v_mfma_f32_16x16x32_bf16 v[68:71], a[196:199], v[144:147], v[68:71]
    v_mfma_f32_16x16x32_bf16 v[96:99], v[20:23], v[144:147], v[96:99]
    s_add_u32 m0, s57, 98304
    s_nop 0
    buffer_load_dwordx4 v200, s[12:15], s81 offen offset:0 lds
    ds_read_b64_tr_b16 a[240:241], v2 offset:28672
    ds_read_b64_tr_b16 a[242:243], v2 offset:30720
    s_waitcnt lgkmcnt(15)
    v_mfma_f32_16x16x32_bf16 v[72:75], a[200:203], v[144:147], v[72:75]
    v_mfma_f32_16x16x32_bf16 v[100:103], v[144:147], v[144:147], v[100:103]
    buffer_load_dwordx4 v201, s[12:15], s81 offen offset:1024 lds
    ds_read_b64_tr_b16 a[244:245], v3 offset:28672
    ds_read_b64_tr_b16 a[246:247], v3 offset:30720
    v_mfma_f32_16x16x32_bf16 v[76:79], a[204:207], v[144:147], v[76:79]
    buffer_load_dwordx4 v202, s[12:15], s81 offen offset:2048 lds
    ds_read_b64_tr_b16 a[248:249], v4 offset:28672
    ds_read_b64_tr_b16 a[250:251], v4 offset:30720
    s_waitcnt lgkmcnt(15)
    v_mfma_f32_16x16x32_bf16 v[64:67], a[208:211], v[148:151], v[64:67]
    v_mfma_f32_16x16x32_bf16 v[80:83], a[208:211], v[20:23], v[80:83]
    buffer_load_dwordx4 v203, s[12:15], s81 offen offset:3072 lds
    ds_read_b64_tr_b16 a[252:253], v5 offset:28672
    ds_read_b64_tr_b16 a[254:255], v5 offset:30720
    v_mfma_f32_16x16x32_bf16 v[68:71], a[212:215], v[148:151], v[68:71]
    s_cmp_lg_u32 s40, 0
    s_nop 6
    s_cbranch_scc1 Lgo_4
    s_waitcnt vmcnt(7)
    v_cmp_ne_u32 vcc, 0, v59
    s_cmp_eq_u32 vcc_lo, 15
    s_nop 3
    s_cbranch_scc1 Lgp_5
    buffer_load_dword v59, v60, s[32:35], 0 offen sc0
    s_branch Lgo_4
Lgp_5:
    s_mov_b64 exec, 1
    s_mov_b32 s40, 1
    buffer_store_byte v56, v57, s[28:31], 0 offen sc1
    s_mov_b64 exec, 0xffff
    buffer_load_dword v61, v58, s[28:31], 0 offen sc1
    s_mov_b64 exec, -1
Lgo_4:
    v_mfma_f32_16x16x32_bf16 v[96:99], v[20:23], v[148:151], v[96:99]
    s_add_u32 m0, s57, 114688
    s_nop 0
    buffer_load_dwordx4 v200, s[12:15], s60 offen offset:0 lds
    s_waitcnt vmcnt(11)
    ds_read_b128 v[160:163], v63 offset:32768
    ds_read_b128 v[164:167], v63 offset:33792
    ds_read_b128 v[168:171], v63 offset:34816
    ds_read_b128 v[172:175], v63 offset:35840
    ds_read_b128 v[176:179], v63 offset:49152
    ds_read_b128 v[180:183], v63 offset:50176
    ds_read_b128 v[184:187], v63 offset:51200
    ds_read_b128 v[188:191], v63 offset:52224
    s_barrier
    ds_read_b64_tr_b16 a[192:193], v2 offset:32768
    ds_read_b64_tr_b16 a[194:195], v2 offset:34816
    s_waitcnt lgkmcnt(15)
    v_mfma_f32_16x16x32_bf16 v[72:75], a[216:219], v[148:151], v[72:75]
    v_mfma_f32_16x16x32_bf16 v[100:103], v[148:151], v[148:151], v[100:103]
    buffer_load_dwordx4 v201, s[12:15], s60 offen offset:1024 lds
    ds_read_b64_tr_b16 a[196:197], v3 offset:32768
    ds_read_b64_tr_b16 a[198:199], v3 offset:34816
    v_mfma_f32_16x16x32_bf16 v[76:79], a[220:223], v[148:151], v[76:79]
    buffer_load_dwordx4 v202, s[12:15], s60 offen offset:2048 lds
    ds_read_b64_tr_b16 a[200:201], v4 offset:32768
    ds_read_b64_tr_b16 a[202:203], v4 offset:34816
    v_mfma_f32_16x16x32_bf16 v[64:67], a[224:227], v[152:155], v[64:67]
    v_mfma_f32_16x16x32_bf16 v[80:83], a[224:227], v[20:23], v[80:83]
    buffer_load_dwordx4 v203, s[12:15], s60 offen offset:3072 lds
    ds_read_b64_tr_b16 a[204:205], v5 offset:32768
    ds_read_b64_tr_b16 a[206:207], v5 offset:34816
    v_mfma_f32_16x16x32_bf16 v[68:71], a[228:231], v[152:155], v[68:71]
    v_mfma_f32_16x16x32_bf16 v[96:99], v[20:23], v[152:155], v[96:99]
    s_waitcnt lgkmcnt(8)
    s_add_u32 m0, s57, 131072
    s_nop 0
    buffer_load_dwordx4 v200, s[12:15], s61 offen offset:0 lds
    ds_read_b64_tr_b16 a[208:209], v2 offset:36864
    ds_read_b64_tr_b16 a[210:211], v2 offset:38912
    v_mfma_f32_16x16x32_bf16 v[72:75], a[232:235], v[152:155], v[72:75]
    v_mfma_f32_16x16x32_bf16 v[100:103], v[152:155], v[152:155], v[100:103]
    buffer_load_dwordx4 v201, s[12:15], s61 offen offset:1024 lds
    ds_read_b64_tr_b16 a[212:213], v3 offset:36864
    ds_read_b64_tr_b16 a[214:215], v3 offset:38912
    v_mfma_f32_16x16x32_bf16 v[76:79], a[236:239], v[152:155], v[76:79]
    buffer_load_dwordx4 v202, s[12:15], s61 offen offset:2048 lds
    ds_read_b64_tr_b16 a[216:217], v4 offset:36864
    ds_read_b64_tr_b16 a[218:219], v4 offset:38912
    v_mfma_f32_16x16x32_bf16 v[64:67], a[240:243], v[156:159], v[64:67]
    v_mfma_f32_16x16x32_bf16 v[80:83], a[240:243], v[20:23], v[80:83]
    s_cmp_lg_u32 s40, 0
    s_nop 6
    s_cbranch_scc1 Lgo_7
    s_waitcnt vmcnt(7)
    v_cmp_ne_u32 vcc, 0, v59
    s_cmp_eq_u32 vcc_lo, 15
    s_nop 3
    s_cbranch_scc1 Lgp_8
    buffer_load_dword v59, v60, s[32:35], 0 offen sc0
    s_branch Lgo_7
Lgp_8:
    s_mov_b64 exec, 1
    s_mov_b32 s40, 1
    buffer_store_byte v56, v57, s[28:31], 0 offen sc1
    s_mov_b64 exec, 0xffff
    buffer_load_dword v61, v58, s[28:31], 0 offen sc1
    s_mov_b64 exec, -1
Lgo_7:
    buffer_load_dwordx4 v203, s[12:15], s61 offen offset:3072 lds
    ds_read_b64_tr_b16 a[220:221], v5 offset:36864
    ds_read_b64_tr_b16 a[222:223], v5 offset:38912
    v_mfma_f32_16x16x32_bf16 v[68:71], a[244:247], v[156:159], v[68:71]
    v_mfma_f32_16x16x32_bf16 v[96:99], v[20:23], v[156:159], v[96:99]
    s_add_u32 m0, s57, 147456
    s_nop 0
    buffer_load_dwordx4 v200, s[12:15], s64 offen offset:0 lds
    ds_read_b64_tr_b16 a[224:225], v2 offset:40960
    ds_read_b64_tr_b16 a[226:227], v2 offset:43008
    v_mfma_f32_16x16x32_bf16 v[72:75], a[248:251], v[156:159], v[72:75]
    v_mfma_f32_16x16x32_bf16 v[100:103], v[156:159], v[156:159], v[100:103]
    buffer_load_dwordx4 v201, s[12:15], s64 offen offset:1024 lds
    ds_read_b64_tr_b16 a[228:229], v3 offset:40960
    ds_read_b64_tr_b16 a[230:231], v3 offset:43008
    v_mfma_f32_16x16x32_bf16 v[76:79], a[252:255], v[156:159], v[76:79]
    buffer_load_dwordx4 v202, s[12:15], s64 offen offset:2048 lds
    ds_read_b64_tr_b16 a[232:233], v4 offset:40960
    ds_read_b64_tr_b16 a[234:235], v4 offset:43008
    s_waitcnt lgkmcnt(15)
    v_mfma_f32_16x16x32_bf16 v[64:67], a[192:195], v[160:163], v[64:67]
    v_mfma_f32_16x16x32_bf16 v[80:83], a[192:195], v[20:23], v[80:83]
    v_mfma_f32_16x16x32_bf16 v[96:99], v[20:23], v[160:163], v[96:99]
    buffer_load_dwordx4 v203, s[12:15], s64 offen offset:3072 lds
    ds_read_b64_tr_b16 a[236:237], v5 offset:40960
    ds_read_b64_tr_b16 a[238:239], v5 offset:43008
    v_mfma_f32_16x16x32_bf16 v[68:71], a[196:199], v[160:163], v[68:71]
    v_mfma_f32_16x16x32_bf16 v[100:103], v[160:163], v[160:163], v[100:103]
    ds_read_b64_tr_b16 a[240:241], v2 offset:45056
    ds_read_b64_tr_b16 a[242:243], v2 offset:47104
    s_waitcnt lgkmcnt(15)
    v_mfma_f32_16x16x32_bf16 v[72:75], a[200:203], v[160:163], v[72:75]
    v_mfma_f32_16x16x32_bf16 v[96:99], v[20:23], v[164:167], v[96:99]
    buffer_load_dword v114, v112, s[16:19], 0 offen
    v_add_u32 v112, 917504, v112
    ds_read_b64_tr_b16 a[244:245], v3 offset:45056
    ds_read_b64_tr_b16 a[246:247], v3 offset:47104
    v_mfma_f32_16x16x32_bf16 v[76:79], a[204:207], v[160:163], v[76:79]
    s_cmp_lg_u32 s40, 0
    s_nop 6
    s_cbranch_scc1 Lgo_10
    s_waitcnt vmcnt(6)
    v_cmp_ne_u32 vcc, 0, v59
    s_cmp_eq_u32 vcc_lo, 15
    s_nop 3
    s_cbranch_scc1 Lgp_11
    buffer_load_dword v59, v60, s[32:35], 0 offen sc0
    s_branch Lgo_10
Lgp_11:
    s_mov_b64 exec, 1
    s_mov_b32 s40, 1
    buffer_store_byte v56, v57, s[28:31], 0 offen sc1
    s_mov_b64 exec, 0xffff
    buffer_load_dword v61, v58, s[28:31], 0 offen sc1
    s_mov_b64 exec, -1
Lgo_10:
    v_mfma_f32_16x16x32_bf16 v[100:103], v[164:167], v[164:167], v[100:103]
    ds_read_b64_tr_b16 a[248:249], v4 offset:45056
    ds_read_b64_tr_b16 a[250:251], v4 offset:47104
    s_waitcnt lgkmcnt(15)
    v_mfma_f32_16x16x32_bf16 v[64:67], a[208:211], v[164:167], v[64:67]
    v_mfma_f32_16x16x32_bf16 v[80:83], a[208:211], v[20:23], v[80:83]
    v_mfma_f32_16x16x32_bf16 v[96:99], v[20:23], v[168:171], v[96:99]
    ds_read_b64_tr_b16 a[252:253], v5 offset:45056
    ds_read_b64_tr_b16 a[254:255], v5 offset:47104
    v_mfma_f32_16x16x32_bf16 v[68:71], a[212:215], v[164:167], v[68:71]
    v_mfma_f32_16x16x32_bf16 v[100:103], v[168:171], v[168:171], v[100:103]
    s_waitcnt vmcnt(19)
    s_barrier
    ds_read_b64_tr_b16 a[192:193], v2 offset:49152
    ds_read_b64_tr_b16 a[194:195], v2 offset:51200
    s_waitcnt lgkmcnt(15)
    v_mfma_f32_16x16x32_bf16 v[72:75], a[216:219], v[164:167], v[72:75]
    v_mfma_f32_16x16x32_bf16 v[96:99], v[20:23], v[172:175], v[96:99]
    ds_read_b64_tr_b16 a[196:197], v3 offset:49152
    ds_read_b64_tr_b16 a[198:199], v3 offset:51200
    v_mfma_f32_16x16x32_bf16 v[76:79], a[220:223], v[164:167], v[76:79]
    v_mfma_f32_16x16x32_bf16 v[100:103], v[172:175], v[172:175], v[100:103]
    ds_read_b64_tr_b16 a[200:201], v4 offset:49152
    ds_read_b64_tr_b16 a[202:203], v4 offset:51200
    s_waitcnt lgkmcnt(15)
    v_mfma_f32_16x16x32_bf16 v[64:67], a[224:227], v[168:171], v[64:67]
    v_mfma_f32_16x16x32_bf16 v[80:83], a[224:227], v[20:23], v[80:83]
    v_mfma_f32_16x16x32_bf16 v[96:99], v[20:23], v[176:179], v[96:99]
    ds_read_b64_tr_b16 a[204:205], v5 offset:49152
    ds_read_b64_tr_b16 a[206:207], v5 offset:51200
    v_mfma_f32_16x16x32_bf16 v[68:71], a[228:231], v[168:171], v[68:71]
    v_mfma_f32_16x16x32_bf16 v[100:103], v[176:179], v[176:179], v[100:103]
    ds_read_b64_tr_b16 a[208:209], v2 offset:53248
    ds_read_b64_tr_b16 a[210:211], v2 offset:55296
    s_waitcnt lgkmcnt(15)
    v_mfma_f32_16x16x32_bf16 v[72:75], a[232:235], v[168:171], v[72:75]
    v_mfma_f32_16x16x32_bf16 v[96:99], v[20:23], v[180:183], v[96:99]
    ds_read_b64_tr_b16 a[212:213], v3 offset:53248
    ds_read_b64_tr_b16 a[214:215], v3 offset:55296
    v_mfma_f32_16x16x32_bf16 v[76:79], a[236:239], v[168:171], v[76:79]
    v_mfma_f32_16x16x32_bf16 v[100:103], v[180:183], v[180:183], v[100:103]
    ds_read_b64_tr_b16 a[216:217], v4 offset:53248
    ds_read_b64_tr_b16 a[218:219], v4 offset:55296
    s_waitcnt lgkmcnt(15)
    v_mfma_f32_16x16x32_bf16 v[64:67], a[240:243], v[172:175], v[64:67]
    v_mfma_f32_16x16x32_bf16 v[80:83], a[240:243], v[20:23], v[80:83]
    v_mfma_f32_16x16x32_bf16 v[96:99], v[20:23], v[184:187], v[96:99]
    ds_read_b64_tr_b16 a[220:221], v5 offset:53248
    ds_read_b64_tr_b16 a[222:223], v5 offset:55296
    v_mfma_f32_16x16x32_bf16 v[68:71], a[244:247], v[172:175], v[68:71]
    v_mfma_f32_16x16x32_bf16 v[100:103], v[184:187], v[184:187], v[100:103]
    ds_read_b64_tr_b16 a[224:225], v2 offset:57344
    ds_read_b64_tr_b16 a[226:227], v2 offset:59392
    s_waitcnt lgkmcnt(15)
    v_mfma_f32_16x16x32_bf16 v[72:75], a[248:251], v[172:175], v[72:75]
    v_mfma_f32_16x16x32_bf16 v[96:99], v[20:23], v[188:191], v[96:99]
    ds_read_b64_tr_b16 a[228:229], v3 offset:57344
    ds_read_b64_tr_b16 a[230:231], v3 offset:59392
    v_mfma_f32_16x16x32_bf16 v[76:79], a[252:255], v[172:175], v[76:79]
    v_mfma_f32_16x16x32_bf16 v[100:103], v[188:191], v[188:191], v[100:103]
    ds_read_b64_tr_b16 a[232:233], v4 offset:57344
    ds_read_b64_tr_b16 a[234:235], v4 offset:59392
    s_waitcnt lgkmcnt(15)
    v_mfma_f32_16x16x32_bf16 v[64:67], a[192:195], v[176:179], v[64:67]
    v_mfma_f32_16x16x32_bf16 v[80:83], a[192:195], v[20:23], v[80:83]
    ds_read_b64_tr_b16 a[236:237], v5 offset:57344
    ds_read_b64_tr_b16 a[238:239], v5 offset:59392
    v_mfma_f32_16x16x32_bf16 v[68:71], a[196:199], v[176:179], v[68:71]
    s_mov_b32 vcc_lo, 1048577
    s_mov_b32 vcc_hi, 268435712
    v_cndmask_b32 v41, 0, v100, vcc
    ds_read_b64_tr_b16 a[240:241], v2 offset:61440
    ds_read_b64_tr_b16 a[242:243], v2 offset:63488
    s_waitcnt lgkmcnt(15)
    v_mfma_f32_16x16x32_bf16 v[72:75], a[200:203], v[176:179], v[72:75]
    s_mov_b32 vcc_lo, 2097154
    s_mov_b32 vcc_hi, 536871424
    v_cndmask_b32 v41, v41, v101, vcc
    ds_read_b64_tr_b16 a[244:245], v3 offset:61440
    ds_read_b64_tr_b16 a[246:247], v3 offset:63488
    v_mfma_f32_16x16x32_bf16 v[76:79], a[204:207], v[176:179], v[76:79]
    s_mov_b32 vcc_lo, 4194308
    s_mov_b32 vcc_hi, 1073742848
    v_cndmask_b32 v41, v41, v102, vcc
    ds_read_b64_tr_b16 a[248:249], v4 offset:61440
    ds_read_b64_tr_b16 a[250:251], v4 offset:63488
    s_waitcnt lgkmcnt(15)
    v_mfma_f32_16x16x32_bf16 v[64:67], a[208:211], v[180:183], v[64:67]
    v_mfma_f32_16x16x32_bf16 v[80:83], a[208:211], v[20:23], v[80:83]
    s_mov_b32 vcc_lo, 8388616
    s_mov_b32 vcc_hi, 2147485696
    v_cndmask_b32 v41, v41, v103, vcc
    ds_read_b64_tr_b16 a[252:253], v5 offset:61440
    ds_read_b64_tr_b16 a[254:255], v5 offset:63488
    v_mfma_f32_16x16x32_bf16 v[68:71], a[212:215], v[180:183], v[68:71]
    v_mov_b32 v42, v41
    s_nop 1
    v_permlane32_swap_b32 v41, v42
    v_add_f32 v41, v41, v42
    s_waitcnt lgkmcnt(15)
    v_mfma_f32_16x16x32_bf16 v[72:75], a[216:219], v[180:183], v[72:75]
    v_mov_b32 v42, v41
    s_nop 1
    v_permlane16_swap_b32 v41, v42
    v_add_f32 v41, v41, v42
    v_mfma_f32_16x16x32_bf16 v[76:79], a[220:223], v[180:183], v[76:79]
    v_mul_f32 v31, 0xbb000000, v96
    v_mul_f32 v44, v31, v31
    v_mov_b32 v45, 0x3b000000
    v_lshrrev_b32 v108, 4, v0
    v_bfe_u32 v109, v0, 2, 2
    s_waitcnt lgkmcnt(12)
    v_mfma_f32_16x16x32_bf16 v[64:67], a[224:227], v[184:187], v[64:67]
    v_mfma_f32_16x16x32_bf16 v[80:83], a[224:227], v[20:23], v[80:83]
    v_fma_f32 v44, v41, v45, -v44
    v_max_f32 v44, 0, v44
    v_add_f32 v44, 0x3727c5ac, v44
    v_and_b32 v110, 3, v0
    v_lshlrev_b32 v111, 9, v108
    v_mfma_f32_16x16x32_bf16 v[68:71], a[228:231], v[184:187], v[68:71]
    v_rsq_f32 v45, v44
    v_sqrt_f32 v30, v44
    v_mul_f32 v28, 0xc0135761, v45
    v_lshl_add_u32 v111, v109, 7, v111
    v_lshl_add_u32 v111, v110, 3, v111
    s_waitcnt lgkmcnt(8)
    v_mfma_f32_16x16x32_bf16 v[72:75], a[232:235], v[184:187], v[72:75]
    v_mul_f32 v44, v45, v45
    v_mul_f32 v44, 0x3d372713, v44
    v_mul_f32 v29, v28, v44
    v_add_u32 v111, 98304, v111
    v_and_b32 v108, 1, v108
    v_mfma_f32_16x16x32_bf16 v[76:79], a[236:239], v[184:187], v[76:79]
    s_lshl_b32 s68, s54, 2
    s_add_u32 s68, s68, s3
    s_lshl_b32 s68, s68, 14
    v_lshrrev_b32 v109, 1, v109
    v_lshl_add_u32 v108, v108, 1, v109
    s_waitcnt lgkmcnt(4)
    v_mfma_f32_16x16x32_bf16 v[64:67], a[240:243], v[188:191], v[64:67]
    v_mfma_f32_16x16x32_bf16 v[80:83], a[240:243], v[20:23], v[80:83]
    s_lshl_b32 s67, s55, 11
    s_add_u32 s67, s67, s68
    s_lshr_b32 s66, s3, 1
    v_xor_b32 v109, 0, v108
    v_lshl_add_u32 v2, v109, 5, v111
    v_mfma_f32_16x16x32_bf16 v[68:71], a[244:247], v[188:191], v[68:71]
    s_lshl_b32 s66, s66, 10
    s_add_u32 s72, s67, s66
    s_xor_b32 s66, s66, 1024
    v_xor_b32 v109, 1, v108
    v_lshl_add_u32 v3, v109, 5, v111
    s_waitcnt lgkmcnt(0)
    v_mfma_f32_16x16x32_bf16 v[72:75], a[248:251], v[188:191], v[72:75]
    s_add_u32 s66, s67, s66
    ds_write_b128 v104, v[80:83]
    v_xor_b32 v109, 2, v108
    v_lshl_add_u32 v4, v109, 5, v111
    v_mfma_f32_16x16x32_bf16 v[76:79], a[252:255], v[188:191], v[76:79]
    v_xor_b32 v109, 3, v108
    v_lshl_add_u32 v5, v109, 5, v111
    s_cmp_lg_u32 s40, 0
    s_nop 4
    s_cbranch_scc1 Lgo_13
    s_waitcnt vmcnt(0)
    s_mov_b32 s41, 0
Lgs_15:
    v_cmp_ne_u32 vcc, 0, v59
    s_cmp_eq_u32 vcc_lo, 15
    s_nop 3
    s_cbranch_scc1 Lgp_14
    buffer_load_dword v59, v60, s[32:35], 0 offen sc1
    s_waitcnt vmcnt(0)
    s_add_u32 s41, s41, 1
    s_cmp_gt_u32 s41, 30000
    s_cbranch_scc1 L_end
    s_branch Lgs_15
Lgp_14:
    s_mov_b64 exec, 1
    s_mov_b32 s40, 1
    buffer_store_byte v56, v57, s[28:31], 0 offen sc1
    s_mov_b64 exec, 0xffff
    buffer_load_dword v61, v58, s[28:31], 0 offen sc1
    s_mov_b64 exec, -1
Lgo_13:
    s_waitcnt vmcnt(1)
    s_waitcnt lgkmcnt(0)
    s_barrier
    ds_read_b128 v[84:87], v105
    ds_read_b128 v[88:91], v106
    ds_read_b128 v[92:95], v107
    buffer_load_dword v59, v62, s[28:31], 0 offen sc0
    s_waitcnt lgkmcnt(0)
    v_pk_fma_f32 v[64:65], v[80:81], v[30:31], v[64:65] op_sel:[0,1,0] op_sel_hi:[1,1,1]
    v_pk_fma_f32 v[66:67], v[82:83], v[30:31], v[66:67] op_sel:[0,1,0] op_sel_hi:[1,1,1]
    v_pk_fma_f32 v[68:69], v[84:85], v[30:31], v[68:69] op_sel:[0,1,0] op_sel_hi:[1,1,1]
    v_pk_fma_f32 v[70:71], v[86:87], v[30:31], v[70:71] op_sel:[0,1,0] op_sel_hi:[1,1,1]
    v_pk_fma_f32 v[72:73], v[88:89], v[30:31], v[72:73] op_sel:[0,1,0] op_sel_hi:[1,1,1]
    v_pk_fma_f32 v[74:75], v[90:91], v[30:31], v[74:75] op_sel:[0,1,0] op_sel_hi:[1,1,1]
    v_pk_fma_f32 v[76:77], v[92:93], v[30:31], v[76:77] op_sel:[0,1,0] op_sel_hi:[1,1,1]
    v_pk_fma_f32 v[78:79], v[94:95], v[30:31], v[78:79] op_sel:[0,1,0] op_sel_hi:[1,1,1]
    v_pk_mul_f32 v[40:41], v[64:65], v[64:65]
    v_pk_mul_f32 v[42:43], v[66:67], v[66:67]
    v_pk_fma_f32 v[40:41], v[40:41], v[28:29], v[28:29] op_sel:[0,1,0] op_sel_hi:[1,1,0]
    v_pk_fma_f32 v[42:43], v[42:43], v[28:29], v[28:29] op_sel:[0,1,0] op_sel_hi:[1,1,0]
    v_pk_mul_f32 v[40:41], v[64:65], v[40:41]
    v_pk_mul_f32 v[42:43], v[66:67], v[42:43]
    v_exp_f32_e64 v40, v40
    v_exp_f32_e64 v41, v41
    v_exp_f32_e64 v42, v42
    v_exp_f32_e64 v43, v43
    v_pk_fma_f32 v[40:41], v[40:41], v[30:31], v[30:31] op_sel:[0,0,0] op_sel_hi:[1,0,0]
    v_pk_fma_f32 v[42:43], v[42:43], v[30:31], v[30:31] op_sel:[0,0,0] op_sel_hi:[1,0,0]
    v_rcp_f32_e64 v40, v40
    v_rcp_f32_e64 v41, v41
    v_rcp_f32_e64 v42, v42
    v_rcp_f32_e64 v43, v43
    v_pk_mul_f32 v[40:41], v[64:65], v[40:41]
    v_pk_mul_f32 v[42:43], v[66:67], v[42:43]
    v_cvt_pk_bf16_f32 v48, v40, v41
    v_cvt_pk_bf16_f32 v49, v42, v43
    v_pk_mul_f32 v[44:45], v[68:69], v[68:69]
    v_pk_mul_f32 v[46:47], v[70:71], v[70:71]
    v_pk_fma_f32 v[44:45], v[44:45], v[28:29], v[28:29] op_sel:[0,1,0] op_sel_hi:[1,1,0]
    v_pk_fma_f32 v[46:47], v[46:47], v[28:29], v[28:29] op_sel:[0,1,0] op_sel_hi:[1,1,0]
    v_pk_mul_f32 v[44:45], v[68:69], v[44:45]
    v_pk_mul_f32 v[46:47], v[70:71], v[46:47]
    v_exp_f32_e64 v44, v44
    v_exp_f32_e64 v45, v45
    v_exp_f32_e64 v46, v46
    v_exp_f32_e64 v47, v47
    v_pk_fma_f32 v[44:45], v[44:45], v[30:31], v[30:31] op_sel:[0,0,0] op_sel_hi:[1,0,0]
    v_pk_fma_f32 v[46:47], v[46:47], v[30:31], v[30:31] op_sel:[0,0,0] op_sel_hi:[1,0,0]
    v_rcp_f32_e64 v44, v44
    v_rcp_f32_e64 v45, v45
    v_rcp_f32_e64 v46, v46
    v_rcp_f32_e64 v47, v47
    v_pk_mul_f32 v[44:45], v[68:69], v[44:45]
    v_pk_mul_f32 v[46:47], v[70:71], v[46:47]
    v_cvt_pk_bf16_f32 v50, v44, v45
    v_cvt_pk_bf16_f32 v51, v46, v47
    v_pk_mul_f32 v[40:41], v[72:73], v[72:73]
    v_pk_mul_f32 v[42:43], v[74:75], v[74:75]
    v_pk_fma_f32 v[40:41], v[40:41], v[28:29], v[28:29] op_sel:[0,1,0] op_sel_hi:[1,1,0]
    v_pk_fma_f32 v[42:43], v[42:43], v[28:29], v[28:29] op_sel:[0,1,0] op_sel_hi:[1,1,0]
    v_pk_mul_f32 v[40:41], v[72:73], v[40:41]
    v_pk_mul_f32 v[42:43], v[74:75], v[42:43]
    v_exp_f32_e64 v40, v40
    v_exp_f32_e64 v41, v41
    v_exp_f32_e64 v42, v42
    v_exp_f32_e64 v43, v43
    v_pk_fma_f32 v[40:41], v[40:41], v[30:31], v[30:31] op_sel:[0,0,0] op_sel_hi:[1,0,0]
    v_pk_fma_f32 v[42:43], v[42:43], v[30:31], v[30:31] op_sel:[0,0,0] op_sel_hi:[1,0,0]
    v_rcp_f32_e64 v40, v40
    v_rcp_f32_e64 v41, v41
    v_rcp_f32_e64 v42, v42
    v_rcp_f32_e64 v43, v43
    v_pk_mul_f32 v[40:41], v[72:73], v[40:41]
    v_pk_mul_f32 v[42:43], v[74:75], v[42:43]
    v_cvt_pk_bf16_f32 v52, v40, v41
    v_cvt_pk_bf16_f32 v53, v42, v43
    v_pk_mul_f32 v[44:45], v[76:77], v[76:77]
    v_pk_mul_f32 v[46:47], v[78:79], v[78:79]
    v_pk_fma_f32 v[44:45], v[44:45], v[28:29], v[28:29] op_sel:[0,1,0] op_sel_hi:[1,1,0]
    v_pk_fma_f32 v[46:47], v[46:47], v[28:29], v[28:29] op_sel:[0,1,0] op_sel_hi:[1,1,0]
    v_pk_mul_f32 v[44:45], v[76:77], v[44:45]
    v_pk_mul_f32 v[46:47], v[78:79], v[46:47]
    v_exp_f32_e64 v44, v44
    v_exp_f32_e64 v45, v45
    v_exp_f32_e64 v46, v46
    v_exp_f32_e64 v47, v47
    v_pk_fma_f32 v[44:45], v[44:45], v[30:31], v[30:31] op_sel:[0,0,0] op_sel_hi:[1,0,0]
    v_pk_fma_f32 v[46:47], v[46:47], v[30:31], v[30:31] op_sel:[0,0,0] op_sel_hi:[1,0,0]
    v_rcp_f32_e64 v44, v44
    v_rcp_f32_e64 v45, v45
    v_rcp_f32_e64 v46, v46
    v_rcp_f32_e64 v47, v47
    v_pk_mul_f32 v[44:45], v[76:77], v[44:45]
    v_pk_mul_f32 v[46:47], v[78:79], v[46:47]
    v_cvt_pk_bf16_f32 v54, v44, v45
    v_cvt_pk_bf16_f32 v55, v46, v47
    s_bitcmp0_b32 s3, 0
    s_nop 1
    s_cbranch_scc1 Lx_16
    v_swap_b32 v48, v50
    v_swap_b32 v49, v51
    v_swap_b32 v52, v54
    v_swap_b32 v53, v55
    s_nop 2
Lx_16:
    buffer_store_dwordx4 v[48:51], v1, s[28:31], s72 offen sc1
    buffer_store_dwordx4 v[52:55], v1, s[28:31], s66 offen sc1
    s_mul_i32 s77, s3, 7168
    s_lshl_b32 s64, s3, 13
    s_add_u32 s64, s64, 131072
    s_and_b32 s76, s3, 1
    s_mul_i32 s76, s76, 114688
    s_lshr_b32 s69, s3, 1
    s_add_u32 s69, s69, s52
    s_add_u32 s4, s69, 0
    s_and_b32 s4, s4, 7
    s_mul_i32 s4, s4, 229376
    s_add_u32 s4, s4, s76
    s_add_u32 s5, s69, 2
    s_and_b32 s5, s5, 7
    s_mul_i32 s5, s5, 229376
    s_add_u32 s5, s5, s76
    s_add_u32 s6, s69, 4
    s_and_b32 s6, s6, 7
    s_mul_i32 s6, s6, 229376
    s_add_u32 s6, s6, s76
    s_add_u32 s7, s69, 6
    s_and_b32 s7, s7, 7
    s_mul_i32 s7, s7, 229376
    s_add_u32 s7, s7, s76
    s_add_u32 s60, s28, 737280
    s_addc_u32 s61, s29, 0
    s_add_u32 s70, s71, 0
    s_and_b32 s70, s70, 3
    s_and_b32 s69, s70, 1
    s_mul_i32 s70, s70, 7
    s_add_u32 s70, s70, s69
    s_lshl_b32 s73, s70, 10
    s_cmp_eq_u32 s69, 0
    s_cselect_b32 s80, 6, -1
    s_lshl_b32 s80, s80, 10
    s_add_u32 s70, s71, 1
    s_and_b32 s70, s70, 3
    s_and_b32 s69, s70, 1
    s_mul_i32 s70, s70, 7
    s_add_u32 s70, s70, s69
    s_lshl_b32 s74, s70, 10
    s_cmp_eq_u32 s69, 0
    s_cselect_b32 s81, 6, -1
    s_lshl_b32 s81, s81, 10
    s_add_u32 s70, s71, 2
    s_and_b32 s70, s70, 3
    s_and_b32 s69, s70, 1
    s_mul_i32 s70, s70, 7
    s_add_u32 s70, s70, s69
    s_lshl_b32 s78, s70, 10
    s_add_u32 s70, s71, 3
    s_and_b32 s70, s70, 3
    s_and_b32 s69, s70, 1
    s_mul_i32 s70, s70, 7
    s_add_u32 s70, s70, s69
    s_lshl_b32 s79, s70, 10
    v_and_b32 v44, 15, v0
    v_lshrrev_b32 v45, 5, v0
    v_bfe_u32 v46, v0, 1, 3
    v_xor_b32 v45, v45, v46
    v_bfe_u32 v46, v0, 4, 1
    v_lshlrev_b32 v44, 7, v44
    v_lshl_add_u32 v44, v46, 3, v44
    v_lshl_add_u32 v44, v45, 4, v44
    s_lshr_b32 s69, s57, 1
    s_add_u32 s69, s69, 86016
    v_add_u32 v96, s69, v44
    v_xor_b32 v97, 32, v96
    v_xor_b32 v98, 64, v96
    v_xor_b32 v99, 96, v96
    ds_read_b64 v[100:101], v96
    ds_read_b64 v[102:103], v97
    ds_read_b64 v[104:105], v98
    ds_read_b64 v[106:107], v99
    s_and_b32 s75, s53, 1
    s_lshl_b32 s65, s54, 2
    s_add_u32 s65, s65, s3
    s_lshl_b32 s65, s65, 10
    s_lshl_b32 s66, s55, 2
    s_add_u32 s66, s66, s65
    s_add_u32 s66, s66, 737280
    ds_read_b64_tr_b16 a[0:1], v2 offset:0
    ds_read_b64_tr_b16 a[2:3], v2 offset:2048
    ds_read_b64_tr_b16 a[4:5], v3 offset:0
    ds_read_b64_tr_b16 a[6:7], v3 offset:2048
    ds_read_b64_tr_b16 a[8:9], v4 offset:0
    ds_read_b64_tr_b16 a[10:11], v4 offset:2048
    ds_read_b64_tr_b16 a[12:13], v5 offset:0
    ds_read_b64_tr_b16 a[14:15], v5 offset:2048
    ds_read_b64_tr_b16 a[16:17], v2 offset:4096
    ds_read_b64_tr_b16 a[18:19], v2 offset:6144
    ds_read_b64_tr_b16 a[20:21], v3 offset:4096
    ds_read_b64_tr_b16 a[22:23], v3 offset:6144
    ds_read_b64_tr_b16 a[24:25], v4 offset:4096
    s_waitcnt lgkmcnt(13)
    v_add_u32 v96, 28672, v96
    v_lshlrev_b32 v64, 16, v100
    v_and_b32 v65, 0xffff0000, v100
    v_lshlrev_b32 v66, 16, v101
    v_and_b32 v67, 0xffff0000, v101
    v_add_u32 v97, 28672, v97
    v_lshlrev_b32 v68, 16, v102
    v_and_b32 v69, 0xffff0000, v102
    v_lshlrev_b32 v70, 16, v103
    v_and_b32 v71, 0xffff0000, v103
    v_add_u32 v98, 28672, v98
    v_lshlrev_b32 v72, 16, v104
    v_and_b32 v73, 0xffff0000, v104
    v_lshlrev_b32 v74, 16, v105
    v_and_b32 v75, 0xffff0000, v105
    v_add_u32 v99, 28672, v99
    v_lshlrev_b32 v76, 16, v106
    v_and_b32 v77, 0xffff0000, v106
    v_lshlrev_b32 v78, 16, v107
    v_and_b32 v79, 0xffff0000, v107
    s_add_u32 s44, s59, 0
    s_and_b32 s44, s44, 7
    s_lshl_b32 s44, s44, 11
    s_add_u32 s44, s44, s68
    s_add_u32 s45, s59, 1
    s_and_b32 s45, s45, 7
    s_lshl_b32 s45, s45, 11
    s_add_u32 s45, s45, s68
    s_add_u32 s46, s59, 2
    s_and_b32 s46, s46, 7
    s_lshl_b32 s46, s46, 11
    s_add_u32 s46, s46, s68
    s_add_u32 s47, s59, 3
    s_and_b32 s47, s47, 7
    s_lshl_b32 s47, s47, 11
    s_add_u32 s47, s47, s68
    s_add_u32 s48, s59, 4
    s_and_b32 s48, s48, 7
    s_lshl_b32 s48, s48, 11
    s_add_u32 s48, s48, s68
    s_add_u32 s49, s59, 5
    s_and_b32 s49, s49, 7
    s_lshl_b32 s49, s49, 11
    s_add_u32 s49, s49, s68
    s_add_u32 s50, s59, 6
    s_and_b32 s50, s50, 7
    s_lshl_b32 s50, s50, 11
    s_add_u32 s50, s50, s68
    s_add_u32 s51, s59, 7
    s_and_b32 s51, s51, 7
    s_lshl_b32 s51, s51, 11
    s_add_u32 s51, s51, s68
    ds_read_b64_tr_b16 a[26:27], v4 offset:6144
    ds_read_b64_tr_b16 a[28:29], v5 offset:4096
    ds_read_b64_tr_b16 a[30:31], v5 offset:6144
    ds_read_b64_tr_b16 a[32:33], v2 offset:8192
    ds_read_b64_tr_b16 a[34:35], v2 offset:10240
    ds_read_b64_tr_b16 a[36:37], v3 offset:8192
    ds_read_b64_tr_b16 a[38:39], v3 offset:10240
    ds_read_b64_tr_b16 a[40:41], v4 offset:8192
    ds_read_b64_tr_b16 a[42:43], v4 offset:10240
    ds_read_b64_tr_b16 a[44:45], v5 offset:8192
    ds_read_b64_tr_b16 a[46:47], v5 offset:10240
    ds_read_b64_tr_b16 a[48:49], v2 offset:12288
    ds_read_b64_tr_b16 a[50:51], v2 offset:14336
    ds_read_b64_tr_b16 a[52:53], v3 offset:12288
    ds_read_b64_tr_b16 a[54:55], v3 offset:14336
    ds_read_b64_tr_b16 a[56:57], v4 offset:12288
    ds_read_b64_tr_b16 a[58:59], v4 offset:14336
    ds_read_b64_tr_b16 a[60:61], v5 offset:12288
    ds_read_b64_tr_b16 a[62:63], v5 offset:14336
    ds_read_b64_tr_b16 a[64:65], v2 offset:16384
    ds_read_b64_tr_b16 a[66:67], v2 offset:18432
    ds_read_b64_tr_b16 a[68:69], v3 offset:16384
    ds_read_b64_tr_b16 a[70:71], v3 offset:18432
    ds_read_b64_tr_b16 a[72:73], v4 offset:16384
    ds_read_b64_tr_b16 a[74:75], v4 offset:18432
    ds_read_b64_tr_b16 a[76:77], v5 offset:16384
    ds_read_b64_tr_b16 a[78:79], v5 offset:18432
    ds_read_b64_tr_b16 a[80:81], v2 offset:20480
    ds_read_b64_tr_b16 a[82:83], v2 offset:22528
    ds_read_b64_tr_b16 a[84:85], v3 offset:20480
    ds_read_b64_tr_b16 a[86:87], v3 offset:22528
    ds_read_b64_tr_b16 a[88:89], v4 offset:20480
    ds_read_b64_tr_b16 a[90:91], v4 offset:22528
    ds_read_b64_tr_b16 a[92:93], v5 offset:20480
    ds_read_b64_tr_b16 a[94:95], v5 offset:22528
    ds_read_b64_tr_b16 a[96:97], v2 offset:24576
    ds_read_b64_tr_b16 a[98:99], v2 offset:26624
    ds_read_b64_tr_b16 a[100:101], v3 offset:24576
    s_waitcnt vmcnt(0)
    v_cmp_eq_u32 vcc, s58, v59
    s_mov_b32 s57, 0
    s_mov_b32 s72, 0
    s_cmp_eq_u32 vcc_lo, 15
    s_nop 1
    s_cbranch_scc1 Lh3_19
Lh_17:
s_load_dwordx4 s[36:39], s[42:43], 0 glc
    s_waitcnt lgkmcnt(0)
    s_and_b64 s[40:41], s[36:37], s[38:39]
    s_and_b32 s40, s40, s41
    s_and_b32 s40, s40, 0x80808080
    s_cmp_eq_u32 s40, 0x80808080
    s_cbranch_scc1 Lh2_18
    s_add_u32 s72, s72, 1
    s_cmp_gt_u32 s72, 30000
    s_cbranch_scc1 L_end
    s_branch Lh_17
Lh2_18:
    s_xor_b32 s36, s36, s58
    s_xor_b32 s37, s37, s58
    s_xor_b32 s38, s38, s58
    s_xor_b32 s39, s39, s58
    s_or_b64 s[36:37], s[36:37], s[38:39]
    s_or_b32 s36, s36, s37
    s_cselect_b32 s57, 4096, 0
Lh3_19:
    s_cmp_lg_u32 s57, 0
    s_cbranch_scc1 Ls_20
    s_mov_b64 exec, 65535
    buffer_store_dword v10, v6, s[28:31], s66 offen
    s_branch Ld_21
Ls_20:
    s_mov_b64 exec, 1
    buffer_store_dword v10, v6, s[28:31], s66 offen sc1
Ld_21:
    s_mov_b64 exec, -1
    ds_read_b64_tr_b16 a[102:103], v3 offset:26624
    ds_read_b64_tr_b16 a[104:105], v4 offset:24576
    ds_read_b64_tr_b16 a[106:107], v4 offset:26624
    ds_read_b64_tr_b16 a[108:109], v5 offset:24576
    s_add_u32 m0, s77, 0
    s_nop 0
    buffer_load_dwordx4 v12, s[16:19], s4 offen offset:0 lds
    ds_read_b64_tr_b16 a[110:111], v5 offset:26624
    ds_read_b64_tr_b16 a[112:113], v2 offset:28672
    ds_read_b64_tr_b16 a[114:115], v2 offset:30720
    ds_read_b64_tr_b16 a[116:117], v3 offset:28672
    ds_read_b64_tr_b16 a[118:119], v3 offset:30720
    buffer_load_dwordx4 v13, s[16:19], s4 offen offset:1024 lds
    ds_read_b64_tr_b16 a[120:121], v4 offset:28672
    ds_read_b64_tr_b16 a[122:123], v4 offset:30720
    ds_read_b64_tr_b16 a[124:125], v5 offset:28672
    ds_read_b64_tr_b16 a[126:127], v5 offset:30720
    ds_read_b64_tr_b16 a[128:129], v2 offset:32768
    buffer_load_dwordx4 v14, s[16:19], s4 offen offset:2048 lds
    ds_read_b64_tr_b16 a[130:131], v2 offset:34816
    ds_read_b64_tr_b16 a[132:133], v3 offset:32768
    ds_read_b64_tr_b16 a[134:135], v3 offset:34816
    ds_read_b64_tr_b16 a[136:137], v4 offset:32768
    ds_read_b64_tr_b16 a[138:139], v4 offset:34816
    buffer_load_dwordx4 v15, s[16:19], s4 offen offset:3072 lds
    ds_read_b64_tr_b16 a[140:141], v5 offset:32768
    ds_read_b64_tr_b16 a[142:143], v5 offset:34816
    ds_read_b64_tr_b16 a[144:145], v2 offset:36864
    ds_read_b64_tr_b16 a[146:147], v2 offset:38912
    ds_read_b64_tr_b16 a[148:149], v3 offset:36864
    s_add_u32 m0, s77, 4096
    s_nop 0
    buffer_load_dwordx4 v16, s[16:19], s4 offen offset:0 lds
    ds_read_b64_tr_b16 a[150:151], v3 offset:38912
    ds_read_b64_tr_b16 a[152:153], v4 offset:36864
    ds_read_b64_tr_b16 a[154:155], v4 offset:38912
    ds_read_b64_tr_b16 a[156:157], v5 offset:36864
    ds_read_b64_tr_b16 a[158:159], v5 offset:38912
    buffer_load_dwordx4 v17, s[16:19], s4 offen offset:1024 lds
    ds_read_b64_tr_b16 a[160:161], v2 offset:40960
    ds_read_b64_tr_b16 a[162:163], v2 offset:43008
    ds_read_b64_tr_b16 a[164:165], v3 offset:40960
    ds_read_b64_tr_b16 a[166:167], v3 offset:43008
    ds_read_b64_tr_b16 a[168:169], v4 offset:40960
    buffer_load_dwordx4 v18, s[16:19], s4 offen offset:2048 lds
    ds_read_b64_tr_b16 a[170:171], v4 offset:43008
    ds_read_b64_tr_b16 a[172:173], v5 offset:40960
    ds_read_b64_tr_b16 a[174:175], v5 offset:43008
    ds_read_b64_tr_b16 a[176:177], v2 offset:45056
    ds_read_b64_tr_b16 a[178:179], v2 offset:47104
    s_add_u32 m0, s77, 28672
    s_nop 0
    buffer_load_dwordx4 v12, s[16:19], s5 offen offset:0 lds
    ds_read_b64_tr_b16 a[180:181], v3 offset:45056
    ds_read_b64_tr_b16 a[182:183], v3 offset:47104
    ds_read_b64_tr_b16 a[184:185], v4 offset:45056
    ds_read_b64_tr_b16 a[186:187], v4 offset:47104
    ds_read_b64_tr_b16 a[188:189], v5 offset:45056
    buffer_load_dwordx4 v13, s[16:19], s5 offen offset:1024 lds
    ds_read_b64_tr_b16 a[190:191], v5 offset:47104
    ds_read_b64_tr_b16 a[192:193], v2 offset:49152
    ds_read_b64_tr_b16 a[194:195], v2 offset:51200
    ds_read_b64_tr_b16 a[196:197], v3 offset:49152
    ds_read_b64_tr_b16 a[198:199], v3 offset:51200
    buffer_load_dwordx4 v14, s[16:19], s5 offen offset:2048 lds
    ds_read_b64_tr_b16 a[200:201], v4 offset:49152
    ds_read_b64_tr_b16 a[202:203], v4 offset:51200
    ds_read_b64_tr_b16 a[204:205], v5 offset:49152
    ds_read_b64_tr_b16 a[206:207], v5 offset:51200
    ds_read_b64_tr_b16 a[208:209], v2 offset:53248
    buffer_load_dwordx4 v15, s[16:19], s5 offen offset:3072 lds
    ds_read_b64_tr_b16 a[210:211], v2 offset:55296
    ds_read_b64_tr_b16 a[212:213], v3 offset:53248
    ds_read_b64_tr_b16 a[214:215], v3 offset:55296
    ds_read_b64_tr_b16 a[216:217], v4 offset:53248
    ds_read_b64_tr_b16 a[218:219], v4 offset:55296
    s_add_u32 m0, s77, 32768
    s_nop 0
    buffer_load_dwordx4 v16, s[16:19], s5 offen offset:0 lds
    ds_read_b64_tr_b16 a[220:221], v5 offset:53248
    ds_read_b64_tr_b16 a[222:223], v5 offset:55296
    ds_read_b64_tr_b16 a[224:225], v2 offset:57344
    ds_read_b64_tr_b16 a[226:227], v2 offset:59392
    ds_read_b64_tr_b16 a[228:229], v3 offset:57344
    buffer_load_dwordx4 v17, s[16:19], s5 offen offset:1024 lds
    ds_read_b64_tr_b16 a[230:231], v3 offset:59392
    ds_read_b64_tr_b16 a[232:233], v4 offset:57344
    ds_read_b64_tr_b16 a[234:235], v4 offset:59392
    ds_read_b64_tr_b16 a[236:237], v5 offset:57344
    ds_read_b64_tr_b16 a[238:239], v5 offset:59392
    buffer_load_dwordx4 v18, s[16:19], s5 offen offset:2048 lds
    ds_read_b64_tr_b16 a[240:241], v2 offset:61440
    ds_read_b64_tr_b16 a[242:243], v2 offset:63488
    ds_read_b64_tr_b16 a[244:245], v3 offset:61440
    ds_read_b64_tr_b16 a[246:247], v3 offset:63488
    ds_read_b64_tr_b16 a[248:249], v4 offset:61440
    ds_read_b64_tr_b16 a[250:251], v4 offset:63488
    ds_read_b64_tr_b16 a[252:253], v5 offset:61440
    ds_read_b64_tr_b16 a[254:255], v5 offset:63488
    s_waitcnt lgkmcnt(0)
    s_barrier
    v_add_u32 v57, 7168, v7
    v_add_u32 v58, 14336, v7
    v_add_u32 v59, 21504, v7
    s_mov_b32 s71, s57
    s_mov_b32 s72, 0
    s_nop 0
Lp_22:
    s_add_u32 s72, s72, 1
    s_cmp_gt_u32 s72, 30000
    s_cbranch_scc1 L_end
    s_cmp_ge_u32 s71, 1024
    s_cbranch_scc1 Lg_25
    s_add_u32 s70, s65, s71
    s_load_dwordx8 s[36:43], s[60:61], s70
    s_add_u32 s71, s71, 64
    s_branch Lw_23
Lg_25:
    s_load_dwordx8 s[36:43], s[60:61], s65 glc
Lw_23:
    s_waitcnt lgkmcnt(0)
    s_and_b64 s[36:37], s[36:37], s[40:41]
    s_and_b64 s[38:39], s[38:39], s[42:43]
    s_and_b64 s[36:37], s[36:37], s[38:39]
    s_and_b32 s36, s36, s37
    s_cbranch_scc0 Lp_22
    buffer_load_dwordx4 v[192:195], v1, s[28:31], s44 offen offset:0 sc1
    buffer_load_dwordx4 v[196:199], v1, s[28:31], s44 offen offset:1024 sc1
    buffer_load_dwordx4 v[200:203], v1, s[28:31], s45 offen offset:0 sc1
    buffer_load_dwordx4 v[204:207], v1, s[28:31], s45 offen offset:1024 sc1
    buffer_load_dwordx4 v[208:211], v1, s[28:31], s46 offen offset:0 sc1
    buffer_load_dwordx4 v[212:215], v1, s[28:31], s46 offen offset:1024 sc1
    buffer_load_dwordx4 v[216:219], v1, s[28:31], s47 offen offset:0 sc1
    buffer_load_dwordx4 v[220:223], v1, s[28:31], s47 offen offset:1024 sc1
    buffer_load_dwordx4 v[224:227], v1, s[28:31], s48 offen offset:0 sc1
    buffer_load_dwordx4 v[228:231], v1, s[28:31], s48 offen offset:1024 sc1
    buffer_load_dwordx4 v[232:235], v1, s[28:31], s49 offen offset:0 sc1
    buffer_load_dwordx4 v[236:239], v1, s[28:31], s49 offen offset:1024 sc1
    buffer_load_dwordx4 v[240:243], v1, s[28:31], s50 offen offset:0 sc1
    buffer_load_dwordx4 v[244:247], v1, s[28:31], s50 offen offset:1024 sc1
    buffer_load_dwordx4 v[248:251], v1, s[28:31], s51 offen offset:0 sc1
    buffer_load_dwordx4 v[252:255], v1, s[28:31], s51 offen offset:1024 sc1
    s_lshl_b32 s65, s54, 1
    s_lshr_b32 s66, s3, 1
    s_add_u32 s65, s65, s66
    s_lshl_b32 s70, s65, 10
    s_lshl_b32 s66, s65, 15
    s_lshl_b32 s67, s55, 12
    s_add_u32 s66, s66, s67
    s_and_b32 s67, s3, 1
    s_lshl_b32 s68, s67, 8
    s_add_u32 s66, s66, s68
    s_add_u32 s66, s66, 131072
    s_lshl_b32 s65, s65, 11
    s_lshl_b32 s68, s55, 8
    s_add_u32 s65, s65, s68
    s_lshl_b32 s68, s67, 7
    s_add_u32 s65, s65, s68
    s_add_u32 s65, s65, 720896
    s_lshl_b32 s67, s67, 3
    s_add_u32 s67, s67, s55
    s_lshl_b32 s67, s67, 2
    s_add_u32 s67, s70, s67
    s_add_u32 s67, s67, 745472
    v_and_b32 v54, 15, v0
    v_lshrrev_b32 v55, 4, v0
    v_lshlrev_b32 v56, 3, v54
    v_lshlrev_b32 v54, 4, v54
    v_lshl_add_u32 v54, v55, 10, v54
    v_lshrrev_b32 v40, 5, v0
    v_bfe_u32 v41, v0, 4, 1
    v_bfe_u32 v42, v0, 2, 2
    v_and_b32 v43, 3, v0
    v_mul_u32_u24 v44, 7168, v40
    v_lshl_add_u32 v45, v42, 6, v44
    v_lshl_add_u32 v45, v41, 5, v45
    v_lshl_add_u32 v2, v43, 3, v45
    v_add_u32 v3, 57344, v2
    v_mul_u32_u24 v45, 896, v41
    v_add_u32 v44, v44, v45
    v_lshl_add_u32 v44, v42, 5, v44
    v_and_b32 v45, 1, v43
    v_lshrrev_b32 v43, 1, v43
    v_lshl_add_u32 v43, v45, 1, v43
    v_lshl_add_u32 v44, v43, 3, v44
    v_add_u32 v4, 768, v44
    v_add_u32 v5, 58112, v44
    v_bfe_u32 v42, v0, 2, 1
    v_cmp_eq_u32 vcc, v42, v41
    s_nop 1
    v_cndmask_b32 v24, 0, v20, vcc
    v_mov_b32 v25, v24
    v_mov_b32 v26, v24
    v_mov_b32 v27, v24
    s_mul_i32 s68, s3, 14336
    v_add_u32 v124, s68, v2
    v_add_u32 v125, s68, v4
    v_and_b32 v48, 31, v0
    v_lshlrev_b32 v48, 3, v48
    v_lshl_add_u32 v48, v40, 10, v48
    s_waitcnt vmcnt(15)
    v_mfma_f32_16x16x32_bf16 v[64:67], a[0:3], v[192:195], v[64:67]
    v_mfma_f32_16x16x32_bf16 v[68:71], a[4:7], v[192:195], v[68:71]
    v_mfma_f32_16x16x32_bf16 v[72:75], a[8:11], v[192:195], v[72:75]
    v_mfma_f32_16x16x32_bf16 v[76:79], a[12:15], v[192:195], v[76:79]
    s_waitcnt vmcnt(14)
    v_mfma_f32_16x16x32_bf16 v[64:67], a[16:19], v[196:199], v[64:67]
    v_mfma_f32_16x16x32_bf16 v[68:71], a[20:23], v[196:199], v[68:71]
    v_mfma_f32_16x16x32_bf16 v[72:75], a[24:27], v[196:199], v[72:75]
    v_mfma_f32_16x16x32_bf16 v[76:79], a[28:31], v[196:199], v[76:79]
    s_waitcnt vmcnt(13)
    v_mfma_f32_16x16x32_bf16 v[64:67], a[32:35], v[200:203], v[64:67]
    v_mfma_f32_16x16x32_bf16 v[68:71], a[36:39], v[200:203], v[68:71]
    v_mfma_f32_16x16x32_bf16 v[72:75], a[40:43], v[200:203], v[72:75]
    v_mfma_f32_16x16x32_bf16 v[76:79], a[44:47], v[200:203], v[76:79]
    s_waitcnt vmcnt(12)
    v_mfma_f32_16x16x32_bf16 v[64:67], a[48:51], v[204:207], v[64:67]
    v_mfma_f32_16x16x32_bf16 v[68:71], a[52:55], v[204:207], v[68:71]
    v_mfma_f32_16x16x32_bf16 v[72:75], a[56:59], v[204:207], v[72:75]
    v_mfma_f32_16x16x32_bf16 v[76:79], a[60:63], v[204:207], v[76:79]
    s_waitcnt vmcnt(11)
    v_mfma_f32_16x16x32_bf16 v[64:67], a[64:67], v[208:211], v[64:67]
    s_add_u32 m0, s77, 57344
    s_nop 0
    buffer_load_dwordx4 v12, s[16:19], s6 offen offset:0 lds
    v_mfma_f32_16x16x32_bf16 v[68:71], a[68:71], v[208:211], v[68:71]
    v_mfma_f32_16x16x32_bf16 v[72:75], a[72:75], v[208:211], v[72:75]
    buffer_load_dwordx4 v13, s[16:19], s6 offen offset:1024 lds
    v_mfma_f32_16x16x32_bf16 v[76:79], a[76:79], v[208:211], v[76:79]
    s_waitcnt vmcnt(12)
    v_mfma_f32_16x16x32_bf16 v[64:67], a[80:83], v[212:215], v[64:67]
    buffer_load_dwordx4 v14, s[16:19], s6 offen offset:2048 lds
    v_mfma_f32_16x16x32_bf16 v[68:71], a[84:87], v[212:215], v[68:71]
    v_mfma_f32_16x16x32_bf16 v[72:75], a[88:91], v[212:215], v[72:75]
    buffer_load_dwordx4 v15, s[16:19], s6 offen offset:3072 lds
    v_mfma_f32_16x16x32_bf16 v[76:79], a[92:95], v[212:215], v[76:79]
    s_waitcnt vmcnt(13)
    v_mfma_f32_16x16x32_bf16 v[64:67], a[96:99], v[216:219], v[64:67]
    s_add_u32 m0, s77, 61440
    s_nop 0
    buffer_load_dwordx4 v16, s[16:19], s6 offen offset:0 lds
    v_mfma_f32_16x16x32_bf16 v[68:71], a[100:103], v[216:219], v[68:71]
    v_mfma_f32_16x16x32_bf16 v[72:75], a[104:107], v[216:219], v[72:75]
    buffer_load_dwordx4 v17, s[16:19], s6 offen offset:1024 lds
    v_mfma_f32_16x16x32_bf16 v[76:79], a[108:111], v[216:219], v[76:79]
    s_waitcnt vmcnt(14)
    v_mfma_f32_16x16x32_bf16 v[64:67], a[112:115], v[220:223], v[64:67]
    buffer_load_dwordx4 v18, s[16:19], s6 offen offset:2048 lds
    v_mfma_f32_16x16x32_bf16 v[68:71], a[116:119], v[220:223], v[68:71]
    v_mfma_f32_16x16x32_bf16 v[72:75], a[120:123], v[220:223], v[72:75]
    s_add_u32 m0, s77, 86016
    s_nop 0
    buffer_load_dwordx4 v12, s[16:19], s7 offen offset:0 lds
    v_mfma_f32_16x16x32_bf16 v[76:79], a[124:127], v[220:223], v[76:79]
    s_waitcnt vmcnt(15)
    v_mfma_f32_16x16x32_bf16 v[64:67], a[128:131], v[224:227], v[64:67]
    buffer_load_dwordx4 v13, s[16:19], s7 offen offset:1024 lds
    v_mfma_f32_16x16x32_bf16 v[68:71], a[132:135], v[224:227], v[68:71]
    v_mfma_f32_16x16x32_bf16 v[72:75], a[136:139], v[224:227], v[72:75]
    buffer_load_dwordx4 v14, s[16:19], s7 offen offset:2048 lds
    v_mfma_f32_16x16x32_bf16 v[76:79], a[140:143], v[224:227], v[76:79]
    s_waitcnt vmcnt(16)
    v_mfma_f32_16x16x32_bf16 v[64:67], a[144:147], v[228:231], v[64:67]
    buffer_load_dwordx4 v15, s[16:19], s7 offen offset:3072 lds
    v_mfma_f32_16x16x32_bf16 v[68:71], a[148:151], v[228:231], v[68:71]
    v_mfma_f32_16x16x32_bf16 v[72:75], a[152:155], v[228:231], v[72:75]
    s_add_u32 m0, s77, 90112
    s_nop 0
    buffer_load_dwordx4 v16, s[16:19], s7 offen offset:0 lds
    v_mfma_f32_16x16x32_bf16 v[76:79], a[156:159], v[228:231], v[76:79]
    s_waitcnt vmcnt(17)
    v_mfma_f32_16x16x32_bf16 v[64:67], a[160:163], v[232:235], v[64:67]
    buffer_load_dwordx4 v17, s[16:19], s7 offen offset:1024 lds
    v_mfma_f32_16x16x32_bf16 v[68:71], a[164:167], v[232:235], v[68:71]
    v_mfma_f32_16x16x32_bf16 v[72:75], a[168:171], v[232:235], v[72:75]
    buffer_load_dwordx4 v18, s[16:19], s7 offen offset:2048 lds
    v_mfma_f32_16x16x32_bf16 v[76:79], a[172:175], v[232:235], v[76:79]
    s_waitcnt vmcnt(18)
    v_mfma_f32_16x16x32_bf16 v[64:67], a[176:179], v[236:239], v[64:67]
    v_mfma_f32_16x16x32_bf16 v[68:71], a[180:183], v[236:239], v[68:71]
    v_mfma_f32_16x16x32_bf16 v[72:75], a[184:187], v[236:239], v[72:75]
    v_mfma_f32_16x16x32_bf16 v[76:79], a[188:191], v[236:239], v[76:79]
    s_waitcnt vmcnt(17)
    v_mfma_f32_16x16x32_bf16 v[64:67], a[192:195], v[240:243], v[64:67]
    v_mfma_f32_16x16x32_bf16 v[68:71], a[196:199], v[240:243], v[68:71]
    v_mfma_f32_16x16x32_bf16 v[72:75], a[200:203], v[240:243], v[72:75]
    v_mfma_f32_16x16x32_bf16 v[76:79], a[204:207], v[240:243], v[76:79]
    s_waitcnt vmcnt(16)
    v_mfma_f32_16x16x32_bf16 v[64:67], a[208:211], v[244:247], v[64:67]
    v_mfma_f32_16x16x32_bf16 v[68:71], a[212:215], v[244:247], v[68:71]
    v_mfma_f32_16x16x32_bf16 v[72:75], a[216:219], v[244:247], v[72:75]
    v_mfma_f32_16x16x32_bf16 v[76:79], a[220:223], v[244:247], v[76:79]
    s_waitcnt vmcnt(15)
    v_mfma_f32_16x16x32_bf16 v[64:67], a[224:227], v[248:251], v[64:67]
    v_mfma_f32_16x16x32_bf16 v[68:71], a[228:231], v[248:251], v[68:71]
    v_mfma_f32_16x16x32_bf16 v[72:75], a[232:235], v[248:251], v[72:75]
    v_mfma_f32_16x16x32_bf16 v[76:79], a[236:239], v[248:251], v[76:79]
    s_waitcnt vmcnt(14)
    v_mfma_f32_16x16x32_bf16 v[64:67], a[240:243], v[252:255], v[64:67]
    v_mfma_f32_16x16x32_bf16 v[68:71], a[244:247], v[252:255], v[68:71]
    v_mfma_f32_16x16x32_bf16 v[72:75], a[248:251], v[252:255], v[72:75]
    v_mfma_f32_16x16x32_bf16 v[76:79], a[252:255], v[252:255], v[76:79]
    s_nop 4
    v_cvt_pk_bf16_f32 v32, v64, v65
    v_cvt_pk_bf16_f32 v33, v66, v67
    v_cvt_pk_bf16_f32 v34, v68, v69
    v_cvt_pk_bf16_f32 v35, v70, v71
    v_cvt_pk_bf16_f32 v36, v72, v73
    v_cvt_pk_bf16_f32 v37, v74, v75
    v_cvt_pk_bf16_f32 v38, v76, v77
    v_cvt_pk_bf16_f32 v39, v78, v79
    buffer_store_dwordx4 v[32:35], v54, s[28:31], s66 offen sc1
    buffer_store_dwordx4 v[36:39], v54, s[28:31], s66 offen offset:512 sc1
    v_dot2_f32_bf16 v40, v32, v20, 0
    v_dot2_f32_bf16 v42, v32, v32, 0
    v_dot2_f32_bf16 v40, v33, v20, v40
    v_dot2_f32_bf16 v42, v33, v33, v42
    v_dot2_f32_bf16 v40, v34, v20, v40
    v_dot2_f32_bf16 v42, v34, v34, v42
    v_dot2_f32_bf16 v40, v35, v20, v40
    v_dot2_f32_bf16 v42, v35, v35, v42
    v_dot2_f32_bf16 v40, v36, v20, v40
    v_dot2_f32_bf16 v42, v36, v36, v42
    v_dot2_f32_bf16 v40, v37, v20, v40
    v_dot2_f32_bf16 v42, v37, v37, v42
    v_dot2_f32_bf16 v40, v38, v20, v40
    v_dot2_f32_bf16 v42, v38, v38, v42
    v_dot2_f32_bf16 v40, v39, v20, v40
    v_dot2_f32_bf16 v42, v39, v39, v42
    s_nop 2
    v_permlane32_swap_b32 v40, v42
    v_add_f32 v40, v40, v42
    v_mov_b32 v41, v40
    s_nop 1
    v_permlane16_swap_b32 v40, v41
    v_add_f32 v40, v40, v41
    v_mov_b32 v41, v40
    s_nop 1
    v_permlane32_swap_b32 v40, v41
    s_mov_b64 exec, 0xffff
    buffer_store_dwordx2 v[40:41], v56, s[28:31], s65 offen sc1
    s_mov_b64 exec, -1
    ds_write_b64 v96, v[32:33]
    ds_write_b64 v97, v[34:35]
    ds_write_b64 v98, v[36:37]
    ds_write_b64 v99, v[38:39]
    s_lshl_b32 s68, s3, 11
    s_add_u32 s68, s68, 720896
    s_lshl_b32 s65, s3, 10
    s_add_u32 s65, s65, 8192
    s_lshl_b32 s69, s3, 15
    s_add_u32 s69, s69, 131072
    s_add_u32 s8, s52, 0
    s_and_b32 s8, s8, 7
    s_lshl_b32 s8, s8, 12
    s_add_u32 s8, s8, s69
    s_add_u32 s9, s52, 1
    s_and_b32 s9, s9, 7
    s_lshl_b32 s9, s9, 12
    s_add_u32 s9, s9, s69
    s_add_u32 s10, s52, 2
    s_and_b32 s10, s10, 7
    s_lshl_b32 s10, s10, 12
    s_add_u32 s10, s10, s69
    s_add_u32 s11, s52, 3
    s_and_b32 s11, s11, 7
    s_lshl_b32 s11, s11, 12
    s_add_u32 s11, s11, s69
    s_add_u32 s12, s52, 4
    s_and_b32 s12, s12, 7
    s_lshl_b32 s12, s12, 12
    s_add_u32 s12, s12, s69
    s_add_u32 s13, s52, 5
    s_and_b32 s13, s13, 7
    s_lshl_b32 s13, s13, 12
    s_add_u32 s13, s13, s69
    s_add_u32 s14, s52, 6
    s_and_b32 s14, s14, 7
    s_lshl_b32 s14, s14, 12
    s_add_u32 s14, s14, s69
    s_add_u32 s15, s52, 7
    s_and_b32 s15, s15, 7
    s_lshl_b32 s15, s15, 12
    s_add_u32 s15, s15, s69
    s_waitcnt vmcnt(0)
    s_cmp_lg_u32 s57, 0
    s_cbranch_scc1 Ls_26
    s_mov_b64 exec, 65535
    buffer_store_dword v10, v6, s[28:31], s67 offen
    s_branch Ld_27
Ls_26:
    s_mov_b64 exec, 1
    buffer_store_dword v10, v6, s[28:31], s67 offen sc1
Ld_27:
    s_mov_b64 exec, -1
    buffer_load_dword v114, v113, s[20:23], 0 offen
    v_add_u32 v113, 229376, v113
    s_mul_i32 s62, s3, 112
    s_mul_i32 s66, s53, 7
    s_add_u32 s62, s62, s66
    s_lshl_b32 s62, s62, 10
    s_add_u32 s62, s62, 262144
    s_lshl_b32 s66, s75, 10
    s_add_u32 s66, s66, s62
    s_cmp_eq_u32 s75, 0
    s_cselect_b32 s69, 6144, 0
    s_add_u32 s62, s62, s69
    s_lshr_b32 s63, s3, 1
    s_lshl_b32 s63, s63, 2
    s_lshr_b32 s69, s53, 2
    s_add_u32 s63, s63, s69
    s_lshl_b32 s63, s63, 11
    s_and_b32 s69, s53, 3
    s_lshl_b32 s69, s69, 3
    s_add_u32 s63, s63, s69
    s_and_b32 s69, s3, 1
    s_lshl_b32 s69, s69, 2
    s_add_u32 s63, s63, s69
    s_add_u32 s63, s63, 753664
    s_mul_i32 s58, s54, 224
    s_mul_i32 s69, s3, 28
    s_add_u32 s58, s58, s69
    s_lshl_b32 s58, s58, 10
    s_add_u32 s58, s58, 262144
    s_add_u32 s4, s58, s73
    s_add_u32 s5, s58, s74
    s_add_u32 s6, s58, s78
    s_add_u32 s7, s58, s79
    s_lshr_b32 s69, s3, 1
    s_mul_i32 s69, s69, 114688
    v_add_u32 v11, s69, v1
    s_sub_u32 s69, 114688, s69
    v_add_u32 v56, s69, v1
    s_lshl_b32 s69, s3, 10
    s_add_u32 s69, s69, 122880
    v_add_u32 v126, s69, v1
    v_add_u32 v127, 122880, v1
    s_lshl_b32 s67, s54, 2
    s_add_u32 s67, s67, s3
    s_lshl_b32 s67, s67, 11
    s_add_u32 s67, s67, 16384
    s_waitcnt lgkmcnt(0)
    s_barrier
    s_add_u32 m0, s64, 0
    s_lshl4_add_u32 s76, s73, 3072
    buffer_load_dwordx4 v7, s[20:23], s76 offen offset:0 lds
    buffer_load_dwordx4 v57, s[20:23], s76 offen offset:1024 lds
    buffer_load_dwordx4 v58, s[20:23], s76 offen offset:2048 lds
    buffer_load_dwordx4 v59, s[20:23], s76 offen offset:3072 lds
    s_add_u32 m0, s64, 4096
    s_lshl4_add_u32 s76, s73, 35840
    buffer_load_dwordx4 v7, s[20:23], s76 offen offset:0 lds
    buffer_load_dwordx4 v57, s[20:23], s76 offen offset:1024 lds
    buffer_load_dwordx4 v58, s[20:23], s76 offen offset:2048 lds
    buffer_load_dwordx4 v59, s[20:23], s76 offen offset:3072 lds
    ds_read_b64_tr_b16 a[224:225], v124 offset:0
    ds_read_b64_tr_b16 a[226:227], v124 offset:3584
    ds_read_b64_tr_b16 a[228:229], v124 offset:256
    ds_read_b64_tr_b16 a[230:231], v124 offset:3840
    ds_read_b64_tr_b16 a[232:233], v124 offset:512
    ds_read_b64_tr_b16 a[234:235], v124 offset:4096
    ds_read_b64_tr_b16 a[236:237], v125 offset:0
    ds_read_b64_tr_b16 a[238:239], v125 offset:3584
    ds_read_b64_tr_b16 a[240:241], v124 offset:896
    ds_read_b64_tr_b16 a[242:243], v124 offset:4480
    ds_read_b64_tr_b16 a[244:245], v124 offset:1152
    ds_read_b64_tr_b16 a[246:247], v124 offset:4736
    ds_read_b64_tr_b16 a[248:249], v124 offset:1408
    ds_read_b64_tr_b16 a[250:251], v124 offset:4992
    s_waitcnt lgkmcnt(10)
    v_mfma_f32_16x16x32_bf16 v[96:99], v[24:27], a[224:227], 0
    ds_read_b64_tr_b16 a[252:253], v124 offset:1792
    ds_read_b64_tr_b16 a[254:255], v124 offset:5376
    v_mfma_f32_16x16x32_bf16 v[100:103], v[24:27], a[228:231], 0
    ds_read_b64_tr_b16 a[224:225], v124 offset:2048
    ds_read_b64_tr_b16 a[226:227], v124 offset:5632
    s_waitcnt lgkmcnt(10)
    v_mfma_f32_16x16x32_bf16 v[104:107], v[24:27], a[232:235], 0
    ds_read_b64_tr_b16 a[228:229], v124 offset:2304
    ds_read_b64_tr_b16 a[230:231], v124 offset:5888
    v_mfma_f32_16x16x32_bf16 v[108:111], v[20:23], a[236:239], 0
    ds_read_b64_tr_b16 a[232:233], v125 offset:1792
    ds_read_b64_tr_b16 a[234:235], v125 offset:5376
    s_waitcnt lgkmcnt(10)
    v_mfma_f32_16x16x32_bf16 v[96:99], v[24:27], a[240:243], v[96:99]
    ds_read_b64_tr_b16 a[236:237], v124 offset:2688
    ds_read_b64_tr_b16 a[238:239], v124 offset:6272
    v_mfma_f32_16x16x32_bf16 v[100:103], v[24:27], a[244:247], v[100:103]
    ds_read_b64_tr_b16 a[240:241], v124 offset:2944
    ds_read_b64_tr_b16 a[242:243], v124 offset:6528
    s_waitcnt lgkmcnt(10)
    v_mfma_f32_16x16x32_bf16 v[104:107], v[24:27], a[248:251], v[104:107]
    ds_read_b64_tr_b16 a[244:245], v124 offset:3200
    ds_read_b64_tr_b16 a[246:247], v124 offset:6784
    v_mfma_f32_16x16x32_bf16 v[96:99], v[24:27], a[252:255], v[96:99]
    ds_read_b64_tr_b16 a[248:249], v124 offset:57344
    ds_read_b64_tr_b16 a[250:251], v124 offset:60928
    s_waitcnt lgkmcnt(10)
    v_mfma_f32_16x16x32_bf16 v[100:103], v[24:27], a[224:227], v[100:103]
    ds_read_b64_tr_b16 a[252:253], v124 offset:57600
    ds_read_b64_tr_b16 a[254:255], v124 offset:61184
    v_mfma_f32_16x16x32_bf16 v[104:107], v[24:27], a[228:231], v[104:107]
    ds_read_b64_tr_b16 a[224:225], v124 offset:57856
    ds_read_b64_tr_b16 a[226:227], v124 offset:61440
    s_waitcnt lgkmcnt(10)
    v_mfma_f32_16x16x32_bf16 v[108:111], v[20:23], a[232:235], v[108:111]
    ds_read_b64_tr_b16 a[228:229], v125 offset:57344
    ds_read_b64_tr_b16 a[230:231], v125 offset:60928
    v_mfma_f32_16x16x32_bf16 v[96:99], v[24:27], a[236:239], v[96:99]
    ds_read_b64_tr_b16 a[232:233], v124 offset:58240
    ds_read_b64_tr_b16 a[234:235], v124 offset:61824
    s_waitcnt lgkmcnt(10)
    v_mfma_f32_16x16x32_bf16 v[100:103], v[24:27], a[240:243], v[100:103]
    ds_read_b64_tr_b16 a[236:237], v124 offset:58496
    ds_read_b64_tr_b16 a[238:239], v124 offset:62080
    v_mfma_f32_16x16x32_bf16 v[104:107], v[24:27], a[244:247], v[104:107]
    ds_read_b64_tr_b16 a[240:241], v124 offset:58752
    ds_read_b64_tr_b16 a[242:243], v124 offset:62336
    s_waitcnt lgkmcnt(10)
    v_mfma_f32_16x16x32_bf16 v[96:99], v[24:27], a[248:251], v[96:99]
    ds_read_b64_tr_b16 a[244:245], v124 offset:59136
    ds_read_b64_tr_b16 a[246:247], v124 offset:62720
    v_mfma_f32_16x16x32_bf16 v[100:103], v[24:27], a[252:255], v[100:103]
    ds_read_b64_tr_b16 a[248:249], v124 offset:59392
    ds_read_b64_tr_b16 a[250:251], v124 offset:62976
    s_waitcnt lgkmcnt(10)
    v_mfma_f32_16x16x32_bf16 v[104:107], v[24:27], a[224:227], v[104:107]
    ds_read_b64_tr_b16 a[252:253], v124 offset:59648
    ds_read_b64_tr_b16 a[254:255], v124 offset:63232
    v_mfma_f32_16x16x32_bf16 v[108:111], v[20:23], a[228:231], v[108:111]
    ds_read_b64_tr_b16 a[224:225], v125 offset:59136
    ds_read_b64_tr_b16 a[226:227], v125 offset:62720
    s_waitcnt lgkmcnt(10)
    v_mfma_f32_16x16x32_bf16 v[96:99], v[24:27], a[232:235], v[96:99]
    ds_read_b64_tr_b16 a[228:229], v124 offset:60032
    ds_read_b64_tr_b16 a[230:231], v124 offset:63616
    v_mfma_f32_16x16x32_bf16 v[100:103], v[24:27], a[236:239], v[100:103]
    ds_read_b64_tr_b16 a[232:233], v124 offset:60288
    ds_read_b64_tr_b16 a[234:235], v124 offset:63872
    s_waitcnt lgkmcnt(10)
    v_mfma_f32_16x16x32_bf16 v[104:107], v[24:27], a[240:243], v[104:107]
    ds_read_b64_tr_b16 a[236:237], v124 offset:60544
    ds_read_b64_tr_b16 a[238:239], v124 offset:64128
    v_mfma_f32_16x16x32_bf16 v[96:99], v[24:27], a[244:247], v[96:99]
    s_waitcnt lgkmcnt(8)
    v_mfma_f32_16x16x32_bf16 v[100:103], v[24:27], a[248:251], v[100:103]
    v_mfma_f32_16x16x32_bf16 v[104:107], v[24:27], a[252:255], v[104:107]
    s_waitcnt lgkmcnt(4)
    v_mfma_f32_16x16x32_bf16 v[108:111], v[20:23], a[224:227], v[108:111]
    v_mfma_f32_16x16x32_bf16 v[96:99], v[24:27], a[228:231], v[96:99]
    s_waitcnt lgkmcnt(0)
    v_mfma_f32_16x16x32_bf16 v[100:103], v[24:27], a[232:235], v[100:103]
    v_mfma_f32_16x16x32_bf16 v[104:107], v[24:27], a[236:239], v[104:107]
    s_nop 4
    v_mov_b32 v40, v96
    s_nop 0
    v_mov_b32 v41, v100
    v_mov_b32 v42, v104
    v_mov_b32 v43, v108
    ds_write_b128 v126, v[40:43]
    s_waitcnt lgkmcnt(0)
    s_barrier
    ds_read_b128 v[96:99], v127 offset:0
    ds_read_b128 v[100:103], v127 offset:1024
    ds_read_b128 v[104:107], v127 offset:2048
    ds_read_b128 v[108:111], v127 offset:3072
    ds_read_b64_tr_b16 a[224:225], v2 offset:0
    ds_read_b64_tr_b16 a[226:227], v2 offset:3584
    ds_read_b64_tr_b16 a[228:229], v2 offset:256
    ds_read_b64_tr_b16 a[230:231], v2 offset:3840
    ds_read_b64_tr_b16 a[232:233], v2 offset:896
    ds_read_b64_tr_b16 a[234:235], v2 offset:4480
    ds_read_b64_tr_b16 a[236:237], v2 offset:1152
    ds_read_b64_tr_b16 a[238:239], v2 offset:4736
    ds_read_b64_tr_b16 a[240:241], v2 offset:1792
    ds_read_b64_tr_b16 a[242:243], v2 offset:5376
    ds_read_b64_tr_b16 a[244:245], v2 offset:2048
    ds_read_b64_tr_b16 a[246:247], v2 offset:5632
    s_mov_b32 s71, s57
    s_mov_b32 s72, 0
    s_cmp_ge_u32 s71, 1024
    s_cbranch_scc1 Lg_32
    s_add_u32 s70, s65, s71
    s_load_dwordx16 s[36:51], s[60:61], s70
    s_add_u32 s71, s71, 64
    s_branch Lb_31
Lg_32:
    s_load_dwordx16 s[36:51], s[60:61], s65 glc
Lb_31:
    s_waitcnt lgkmcnt(12)
    v_pk_add_f32 v[96:97], v[96:97], v[100:101]
    v_pk_add_f32 v[104:105], v[104:105], v[108:109]
    v_pk_add_f32 v[98:99], v[98:99], v[102:103]
    v_pk_add_f32 v[106:107], v[106:107], v[110:111]
    v_pk_add_f32 v[96:97], v[96:97], v[104:105]
    v_pk_add_f32 v[98:99], v[98:99], v[106:107]
    v_cvt_pk_bf16_f32 v12, v96, v96
    v_and_b32 v40, 0xffff0000, v12
    v_sub_f32 v40, v96, v40
    v_cvt_pk_bf16_f32 v13, v40, v40
    v_cvt_pk_bf16_f32 v14, v97, v97
    v_and_b32 v40, 0xffff0000, v14
    v_sub_f32 v40, v97, v40
    v_cvt_pk_bf16_f32 v15, v40, v40
    v_cvt_pk_bf16_f32 v16, v98, v98
    v_and_b32 v40, 0xffff0000, v16
    v_sub_f32 v40, v98, v40
    v_cvt_pk_bf16_f32 v17, v40, v40
    v_cvt_pk_bf16_f32 v18, v99, v99
    v_and_b32 v40, 0xffff0000, v18
    v_sub_f32 v40, v99, v40
    v_cvt_pk_bf16_f32 v19, v40, v40
    v_mov_b32 v20, 0
    v_mov_b32 v21, 0
    v_mov_b32 v22, 0
    v_mov_b32 v24, 0
    v_mov_b32 v25, 0
    v_mov_b32 v122, 0
    v_mov_b32 v123, 0
    s_nop 2
    s_branch Lw_29
Lp_28:
    s_add_u32 s72, s72, 1
    s_cmp_gt_u32 s72, 30000
    s_cbranch_scc1 L_end
    s_cmp_ge_u32 s71, 1024
    s_cbranch_scc1 Lg_33
    s_add_u32 s70, s65, s71
    s_load_dwordx16 s[36:51], s[60:61], s70
    s_add_u32 s71, s71, 64
    s_branch Lw_29
Lg_33:
    s_load_dwordx16 s[36:51], s[60:61], s65 glc
Lw_29:
    s_waitcnt lgkmcnt(0)
    s_and_b64 s[36:37], s[36:37], s[44:45]
    s_and_b64 s[38:39], s[38:39], s[46:47]
    s_and_b64 s[40:41], s[40:41], s[48:49]
    s_and_b64 s[42:43], s[42:43], s[50:51]
    s_and_b64 s[36:37], s[36:37], s[40:41]
    s_and_b64 s[38:39], s[38:39], s[42:43]
    s_and_b64 s[36:37], s[36:37], s[38:39]
    s_and_b32 s36, s36, s37
    s_cbranch_scc0 Lp_28
    buffer_load_dwordx4 v[128:131], v1, s[28:31], s8 offen offset:0 sc1
    buffer_load_dwordx4 v[132:135], v1, s[28:31], s8 offen offset:1024 sc1
    buffer_load_dwordx4 v[136:139], v1, s[28:31], s8 offen offset:2048 sc1
    buffer_load_dwordx4 v[140:143], v1, s[28:31], s8 offen offset:3072 sc1
    buffer_load_dwordx2 v[40:41], v48, s[28:31], s68 offen offset:0 sc1
    buffer_load_dwordx2 v[42:43], v48, s[28:31], s68 offen offset:256 sc1
    buffer_load_dwordx2 v[44:45], v48, s[28:31], s68 offen offset:512 sc1
    buffer_load_dwordx2 v[46:47], v48, s[28:31], s68 offen offset:768 sc1
    buffer_load_dwordx4 v[144:147], v1, s[28:31], s9 offen offset:0 sc1
    buffer_load_dwordx4 v[148:151], v1, s[28:31], s9 offen offset:1024 sc1
    buffer_load_dwordx4 v[152:155], v1, s[28:31], s9 offen offset:2048 sc1
    buffer_load_dwordx4 v[156:159], v1, s[28:31], s9 offen offset:3072 sc1
    buffer_load_dwordx4 v[160:163], v1, s[28:31], s10 offen offset:0 sc1
    buffer_load_dwordx4 v[164:167], v1, s[28:31], s10 offen offset:1024 sc1
    buffer_load_dwordx4 v[168:171], v1, s[28:31], s10 offen offset:2048 sc1
    buffer_load_dwordx4 v[172:175], v1, s[28:31], s10 offen offset:3072 sc1
    ds_read_b64_tr_b16 a[248:249], v2 offset:2688
    ds_read_b64_tr_b16 a[250:251], v2 offset:6272
    ds_read_b64_tr_b16 a[252:253], v2 offset:2944
    ds_read_b64_tr_b16 a[254:255], v2 offset:6528
    s_waitcnt vmcnt(15)
    v_mfma_f32_32x32x16_bf16 v[64:79], a[224:227], v[128:131], 0
    buffer_load_dwordx4 v[176:179], v1, s[28:31], s11 offen offset:0 sc1
    v_mfma_f32_32x32x16_bf16 v[80:95], a[228:231], v[128:131], 0
    ds_read_b64_tr_b16 a[224:225], v2 offset:14336
    ds_read_b64_tr_b16 a[226:227], v2 offset:17920
    ds_read_b64_tr_b16 a[228:229], v2 offset:14592
    ds_read_b64_tr_b16 a[230:231], v2 offset:18176
    s_waitcnt vmcnt(15)
    v_mfma_f32_32x32x16_bf16 v[64:79], a[232:235], v[132:135], v[64:79]
    buffer_load_dwordx4 v[180:183], v1, s[28:31], s11 offen offset:1024 sc1
    v_mfma_f32_32x32x16_bf16 v[80:95], a[236:239], v[132:135], v[80:95]
    ds_read_b64_tr_b16 a[232:233], v2 offset:15232
    ds_read_b64_tr_b16 a[234:235], v2 offset:18816
    ds_read_b64_tr_b16 a[236:237], v2 offset:15488
    ds_read_b64_tr_b16 a[238:239], v2 offset:19072
    s_waitcnt vmcnt(15)
    v_mfma_f32_32x32x16_bf16 v[64:79], a[240:243], v[136:139], v[64:79]
    buffer_load_dwordx4 v[184:187], v1, s[28:31], s11 offen offset:2048 sc1
    v_mfma_f32_32x32x16_bf16 v[80:95], a[244:247], v[136:139], v[80:95]
    ds_read_b64_tr_b16 a[240:241], v2 offset:16128
    ds_read_b64_tr_b16 a[242:243], v2 offset:19712
    ds_read_b64_tr_b16 a[244:245], v2 offset:16384
    ds_read_b64_tr_b16 a[246:247], v2 offset:19968
    s_waitcnt vmcnt(15)
    s_waitcnt lgkmcnt(12)
    v_mfma_f32_32x32x16_bf16 v[64:79], a[248:251], v[140:143], v[64:79]
    buffer_load_dwordx4 v[188:191], v1, s[28:31], s11 offen offset:3072 sc1
    v_mfma_f32_32x32x16_bf16 v[80:95], a[252:255], v[140:143], v[80:95]
    ds_read_b64_tr_b16 a[248:249], v2 offset:17024
    ds_read_b64_tr_b16 a[250:251], v2 offset:20608
    ds_read_b64_tr_b16 a[252:253], v2 offset:17280
    ds_read_b64_tr_b16 a[254:255], v2 offset:20864
    s_waitcnt vmcnt(11)
    s_waitcnt lgkmcnt(12)
    v_mfma_f32_32x32x16_bf16 v[64:79], a[224:227], v[144:147], v[64:79]
    buffer_load_dwordx4 v[192:195], v1, s[28:31], s12 offen offset:0 sc1
    v_mfma_f32_32x32x16_bf16 v[80:95], a[228:231], v[144:147], v[80:95]
    ds_read_b64_tr_b16 a[224:225], v2 offset:28672
    ds_read_b64_tr_b16 a[226:227], v2 offset:32256
    ds_read_b64_tr_b16 a[228:229], v2 offset:28928
    ds_read_b64_tr_b16 a[230:231], v2 offset:32512
    s_waitcnt vmcnt(11)
    s_waitcnt lgkmcnt(12)
    v_mfma_f32_32x32x16_bf16 v[64:79], a[232:235], v[148:151], v[64:79]
    buffer_load_dwordx4 v[196:199], v1, s[28:31], s12 offen offset:1024 sc1
    v_mfma_f32_32x32x16_bf16 v[80:95], a[236:239], v[148:151], v[80:95]
    ds_read_b64_tr_b16 a[232:233], v2 offset:29568
    ds_read_b64_tr_b16 a[234:235], v2 offset:33152
    ds_read_b64_tr_b16 a[236:237], v2 offset:29824
    ds_read_b64_tr_b16 a[238:239], v2 offset:33408
    s_waitcnt vmcnt(11)
    s_waitcnt lgkmcnt(12)
    v_mfma_f32_32x32x16_bf16 v[64:79], a[240:243], v[152:155], v[64:79]
    buffer_load_dwordx4 v[200:203], v1, s[28:31], s12 offen offset:2048 sc1
    v_mfma_f32_32x32x16_bf16 v[80:95], a[244:247], v[152:155], v[80:95]
    ds_read_b64_tr_b16 a[240:241], v2 offset:30464
    ds_read_b64_tr_b16 a[242:243], v2 offset:34048
    ds_read_b64_tr_b16 a[244:245], v2 offset:30720
    ds_read_b64_tr_b16 a[246:247], v2 offset:34304
    s_waitcnt vmcnt(11)
    s_waitcnt lgkmcnt(12)
    v_mfma_f32_32x32x16_bf16 v[64:79], a[248:251], v[156:159], v[64:79]
    buffer_load_dwordx4 v[204:207], v1, s[28:31], s12 offen offset:3072 sc1
    v_mfma_f32_32x32x16_bf16 v[80:95], a[252:255], v[156:159], v[80:95]
    ds_read_b64_tr_b16 a[248:249], v2 offset:31360
    ds_read_b64_tr_b16 a[250:251], v2 offset:34944
    ds_read_b64_tr_b16 a[252:253], v2 offset:31616
    ds_read_b64_tr_b16 a[254:255], v2 offset:35200
    s_waitcnt vmcnt(11)
    s_waitcnt lgkmcnt(12)
    v_mfma_f32_32x32x16_bf16 v[64:79], a[224:227], v[160:163], v[64:79]
    buffer_load_dwordx4 v[208:211], v1, s[28:31], s13 offen offset:0 sc1
    v_mfma_f32_32x32x16_bf16 v[80:95], a[228:231], v[160:163], v[80:95]
    ds_read_b64_tr_b16 a[224:225], v2 offset:43008
    ds_read_b64_tr_b16 a[226:227], v2 offset:46592
    ds_read_b64_tr_b16 a[228:229], v2 offset:43264
    ds_read_b64_tr_b16 a[230:231], v2 offset:46848
    s_waitcnt vmcnt(11)
    s_waitcnt lgkmcnt(12)
    v_mfma_f32_32x32x16_bf16 v[64:79], a[232:235], v[164:167], v[64:79]
    buffer_load_dwordx4 v[212:215], v1, s[28:31], s13 offen offset:1024 sc1
    v_mfma_f32_32x32x16_bf16 v[80:95], a[236:239], v[164:167], v[80:95]
    ds_read_b64_tr_b16 a[232:233], v2 offset:43904
    ds_read_b64_tr_b16 a[234:235], v2 offset:47488
    ds_read_b64_tr_b16 a[236:237], v2 offset:44160
    ds_read_b64_tr_b16 a[238:239], v2 offset:47744
    s_waitcnt vmcnt(11)
    s_waitcnt lgkmcnt(12)
    v_mfma_f32_32x32x16_bf16 v[64:79], a[240:243], v[168:171], v[64:79]
    buffer_load_dwordx4 v[216:219], v1, s[28:31], s13 offen offset:2048 sc1
    v_mfma_f32_32x32x16_bf16 v[80:95], a[244:247], v[168:171], v[80:95]
    ds_read_b64_tr_b16 a[240:241], v2 offset:44800
    ds_read_b64_tr_b16 a[242:243], v2 offset:48384
    ds_read_b64_tr_b16 a[244:245], v2 offset:45056
    ds_read_b64_tr_b16 a[246:247], v2 offset:48640
    s_waitcnt vmcnt(11)
    s_waitcnt lgkmcnt(12)
    v_mfma_f32_32x32x16_bf16 v[64:79], a[248:251], v[172:175], v[64:79]
    buffer_load_dwordx4 v[220:223], v1, s[28:31], s13 offen offset:3072 sc1
    v_mfma_f32_32x32x16_bf16 v[80:95], a[252:255], v[172:175], v[80:95]
    ds_read_b64_tr_b16 a[0:1], v8 offset:0
    ds_read_b64_tr_b16 a[4:5], v9 offset:0
    ds_read_b64_tr_b16 a[2:3], v8 offset:1024
    ds_read_b64_tr_b16 a[6:7], v9 offset:1024
    ds_read_b64_tr_b16 a[248:249], v2 offset:45696
    ds_read_b64_tr_b16 a[250:251], v2 offset:49280
    ds_read_b64_tr_b16 a[252:253], v2 offset:45952
    ds_read_b64_tr_b16 a[254:255], v2 offset:49536
    s_waitcnt vmcnt(11)
    s_waitcnt lgkmcnt(15)
    v_mfma_f32_32x32x16_bf16 v[64:79], a[224:227], v[176:179], v[64:79]
    buffer_load_dwordx4 v[224:227], v1, s[28:31], s14 offen offset:0 sc1
    v_mfma_f32_32x32x16_bf16 v[80:95], a[228:231], v[176:179], v[80:95]
    ds_read_b64_tr_b16 a[8:9], v8 offset:2048
    ds_read_b64_tr_b16 a[12:13], v9 offset:2048
    ds_read_b64_tr_b16 a[10:11], v8 offset:3072
    ds_read_b64_tr_b16 a[14:15], v9 offset:3072
    ds_read_b64_tr_b16 a[224:225], v3 offset:0
    ds_read_b64_tr_b16 a[226:227], v3 offset:3584
    ds_read_b64_tr_b16 a[228:229], v3 offset:256
    ds_read_b64_tr_b16 a[230:231], v3 offset:3840
    s_waitcnt vmcnt(11)
    s_waitcnt lgkmcnt(15)
    v_mfma_f32_32x32x16_bf16 v[64:79], a[232:235], v[180:183], v[64:79]
    buffer_load_dwordx4 v[228:231], v1, s[28:31], s14 offen offset:1024 sc1
    v_mfma_f32_32x32x16_bf16 v[80:95], a[236:239], v[180:183], v[80:95]
    ds_read_b64_tr_b16 a[16:17], v8 offset:4096
    ds_read_b64_tr_b16 a[20:21], v9 offset:4096
    ds_read_b64_tr_b16 a[18:19], v8 offset:5120
    ds_read_b64_tr_b16 a[22:23], v9 offset:5120
    ds_read_b64_tr_b16 a[232:233], v3 offset:896
    ds_read_b64_tr_b16 a[234:235], v3 offset:4480
    ds_read_b64_tr_b16 a[236:237], v3 offset:1152
    ds_read_b64_tr_b16 a[238:239], v3 offset:4736
    s_waitcnt vmcnt(11)
    v_mfma_f32_32x32x16_bf16 v[64:79], a[240:243], v[184:187], v[64:79]
    buffer_load_dwordx4 v[232:235], v1, s[28:31], s14 offen offset:2048 sc1
    v_mfma_f32_32x32x16_bf16 v[80:95], a[244:247], v[184:187], v[80:95]
    ds_read_b64_tr_b16 a[24:25], v8 offset:6144
    ds_read_b64_tr_b16 a[28:29], v9 offset:6144
    ds_read_b64_tr_b16 a[26:27], v8 offset:7168
    ds_read_b64_tr_b16 a[30:31], v9 offset:7168
    ds_read_b64_tr_b16 a[240:241], v3 offset:1792
    ds_read_b64_tr_b16 a[242:243], v3 offset:5376
    ds_read_b64_tr_b16 a[244:245], v3 offset:2048
    ds_read_b64_tr_b16 a[246:247], v3 offset:5632
    s_waitcnt vmcnt(11)
    s_waitcnt lgkmcnt(15)
    v_mfma_f32_32x32x16_bf16 v[64:79], a[248:251], v[188:191], v[64:79]
    buffer_load_dwordx4 v[236:239], v1, s[28:31], s14 offen offset:3072 sc1
    v_mfma_f32_32x32x16_bf16 v[80:95], a[252:255], v[188:191], v[80:95]
    ds_read_b64_tr_b16 a[248:249], v3 offset:2688
    ds_read_b64_tr_b16 a[250:251], v3 offset:6272
    ds_read_b64_tr_b16 a[252:253], v3 offset:2944
    ds_read_b64_tr_b16 a[254:255], v3 offset:6528
    s_waitcnt vmcnt(11)
    v_mfma_f32_32x32x16_bf16 v[64:79], a[224:227], v[192:195], v[64:79]
    buffer_load_dwordx4 v[240:243], v1, s[28:31], s15 offen offset:0 sc1
    v_mfma_f32_32x32x16_bf16 v[80:95], a[228:231], v[192:195], v[80:95]
    ds_read_b64_tr_b16 a[224:225], v3 offset:14336
    ds_read_b64_tr_b16 a[226:227], v3 offset:17920
    ds_read_b64_tr_b16 a[228:229], v3 offset:14592
    ds_read_b64_tr_b16 a[230:231], v3 offset:18176
    s_waitcnt vmcnt(11)
    s_waitcnt lgkmcnt(15)
    v_mfma_f32_32x32x16_bf16 v[64:79], a[232:235], v[196:199], v[64:79]
    buffer_load_dwordx4 v[244:247], v1, s[28:31], s15 offen offset:1024 sc1
    v_mfma_f32_32x32x16_bf16 v[80:95], a[236:239], v[196:199], v[80:95]
    ds_read_b64_tr_b16 a[232:233], v3 offset:15232
    ds_read_b64_tr_b16 a[234:235], v3 offset:18816
    ds_read_b64_tr_b16 a[236:237], v3 offset:15488
    ds_read_b64_tr_b16 a[238:239], v3 offset:19072
    s_waitcnt vmcnt(11)
    s_waitcnt lgkmcnt(12)
    v_mfma_f32_32x32x16_bf16 v[64:79], a[240:243], v[200:203], v[64:79]
    buffer_load_dwordx4 v[248:251], v1, s[28:31], s15 offen offset:2048 sc1
    v_mfma_f32_32x32x16_bf16 v[80:95], a[244:247], v[200:203], v[80:95]
    ds_read_b64_tr_b16 a[240:241], v3 offset:16128
    ds_read_b64_tr_b16 a[242:243], v3 offset:19712
    ds_read_b64_tr_b16 a[244:245], v3 offset:16384
    ds_read_b64_tr_b16 a[246:247], v3 offset:19968
    s_waitcnt vmcnt(11)
    s_waitcnt lgkmcnt(12)
    v_mfma_f32_32x32x16_bf16 v[64:79], a[248:251], v[204:207], v[64:79]
    buffer_load_dwordx4 v[252:255], v1, s[28:31], s15 offen offset:3072 sc1
    v_mfma_f32_32x32x16_bf16 v[80:95], a[252:255], v[204:207], v[80:95]
    ds_read_b64_tr_b16 a[248:249], v3 offset:17024
    ds_read_b64_tr_b16 a[250:251], v3 offset:20608
    ds_read_b64_tr_b16 a[252:253], v3 offset:17280
    ds_read_b64_tr_b16 a[254:255], v3 offset:20864
    s_waitcnt vmcnt(11)
    s_waitcnt lgkmcnt(12)
    v_mfma_f32_32x32x16_bf16 v[64:79], a[224:227], v[208:211], v[64:79]
    s_add_u32 m0, s64, 0
    s_lshl4_add_u32 s76, s74, 3072
    buffer_load_dwordx4 v7, s[20:23], s76 offen offset:0 lds
    v_mfma_f32_32x32x16_bf16 v[80:95], a[228:231], v[208:211], v[80:95]
    buffer_load_dwordx4 v57, s[20:23], s76 offen offset:1024 lds
    ds_read_b64_tr_b16 a[224:225], v3 offset:28672
    ds_read_b64_tr_b16 a[226:227], v3 offset:32256
    ds_read_b64_tr_b16 a[228:229], v3 offset:28928
    ds_read_b64_tr_b16 a[230:231], v3 offset:32512
    s_waitcnt vmcnt(12)
    s_waitcnt lgkmcnt(12)
    v_mfma_f32_32x32x16_bf16 v[64:79], a[232:235], v[212:215], v[64:79]
    buffer_load_dwordx4 v58, s[20:23], s76 offen offset:2048 lds
    v_mfma_f32_32x32x16_bf16 v[80:95], a[236:239], v[212:215], v[80:95]
    buffer_load_dwordx4 v59, s[20:23], s76 offen offset:3072 lds
    ds_read_b64_tr_b16 a[232:233], v3 offset:29568
    ds_read_b64_tr_b16 a[234:235], v3 offset:33152
    ds_read_b64_tr_b16 a[236:237], v3 offset:29824
    ds_read_b64_tr_b16 a[238:239], v3 offset:33408
    s_waitcnt vmcnt(13)
    s_waitcnt lgkmcnt(12)
    v_mfma_f32_32x32x16_bf16 v[64:79], a[240:243], v[216:219], v[64:79]
    s_add_u32 m0, s64, 4096
    s_lshl4_add_u32 s76, s74, 35840
    buffer_load_dwordx4 v7, s[20:23], s76 offen offset:0 lds
    v_mfma_f32_32x32x16_bf16 v[80:95], a[244:247], v[216:219], v[80:95]
    buffer_load_dwordx4 v57, s[20:23], s76 offen offset:1024 lds
    ds_read_b64_tr_b16 a[240:241], v3 offset:30464
    ds_read_b64_tr_b16 a[242:243], v3 offset:34048
    ds_read_b64_tr_b16 a[244:245], v3 offset:30720
    ds_read_b64_tr_b16 a[246:247], v3 offset:34304
    s_waitcnt vmcnt(14)
    s_waitcnt lgkmcnt(12)
    v_mfma_f32_32x32x16_bf16 v[64:79], a[248:251], v[220:223], v[64:79]
    buffer_load_dwordx4 v58, s[20:23], s76 offen offset:2048 lds
    v_mfma_f32_32x32x16_bf16 v[80:95], a[252:255], v[220:223], v[80:95]
    buffer_load_dwordx4 v59, s[20:23], s76 offen offset:3072 lds
    ds_read_b64_tr_b16 a[248:249], v3 offset:31360
    ds_read_b64_tr_b16 a[250:251], v3 offset:34944
    ds_read_b64_tr_b16 a[252:253], v3 offset:31616
    ds_read_b64_tr_b16 a[254:255], v3 offset:35200
    s_waitcnt vmcnt(15)
    s_waitcnt lgkmcnt(12)
    v_mfma_f32_32x32x16_bf16 v[64:79], a[224:227], v[224:227], v[64:79]
    v_mfma_f32_32x32x16_bf16 v[80:95], a[228:231], v[224:227], v[80:95]
    ds_read_b64_tr_b16 a[224:225], v3 offset:43008
    ds_read_b64_tr_b16 a[226:227], v3 offset:46592
    ds_read_b64_tr_b16 a[228:229], v3 offset:43264
    ds_read_b64_tr_b16 a[230:231], v3 offset:46848
    s_waitcnt vmcnt(14)
    s_waitcnt lgkmcnt(12)
    v_mfma_f32_32x32x16_bf16 v[64:79], a[232:235], v[228:231], v[64:79]
    v_mfma_f32_32x32x16_bf16 v[80:95], a[236:239], v[228:231], v[80:95]
    ds_read_b64_tr_b16 a[232:233], v3 offset:43904
    ds_read_b64_tr_b16 a[234:235], v3 offset:47488
    ds_read_b64_tr_b16 a[236:237], v3 offset:44160
    ds_read_b64_tr_b16 a[238:239], v3 offset:47744
    s_waitcnt vmcnt(13)
    s_waitcnt lgkmcnt(12)
    v_mfma_f32_32x32x16_bf16 v[64:79], a[240:243], v[232:235], v[64:79]
    v_add_f32 v40, v40, v42
    v_add_f32 v41, v41, v43
    v_add_f32 v44, v44, v46
    v_mfma_f32_32x32x16_bf16 v[80:95], a[244:247], v[232:235], v[80:95]
    v_add_f32 v45, v45, v47
    v_add_f32 v40, v40, v44
    v_add_f32 v41, v41, v45
    ds_read_b64_tr_b16 a[240:241], v3 offset:44800
    ds_read_b64_tr_b16 a[242:243], v3 offset:48384
    ds_read_b64_tr_b16 a[244:245], v3 offset:45056
    ds_read_b64_tr_b16 a[246:247], v3 offset:48640
    s_waitcnt vmcnt(12)
    s_waitcnt lgkmcnt(12)
    v_mfma_f32_32x32x16_bf16 v[64:79], a[248:251], v[236:239], v[64:79]
    v_mov_b32 v42, v40
    v_mov_b32 v43, v41
    s_nop 0
    v_permlane32_swap_b32 v40, v42
    v_mfma_f32_32x32x16_bf16 v[80:95], a[252:255], v[236:239], v[80:95]
    v_permlane32_swap_b32 v41, v43
    v_add_f32 v40, v40, v42
    v_add_f32 v41, v41, v43
    ds_read_b64_tr_b16 a[248:249], v3 offset:45696
    ds_read_b64_tr_b16 a[250:251], v3 offset:49280
    ds_read_b64_tr_b16 a[252:253], v3 offset:45952
    ds_read_b64_tr_b16 a[254:255], v3 offset:49536
    s_waitcnt vmcnt(11)
    s_waitcnt lgkmcnt(12)
    v_mfma_f32_32x32x16_bf16 v[64:79], a[224:227], v[240:243], v[64:79]
    v_mul_f32 v31, 0xbb000000, v40
    v_mul_f32 v42, v31, v31
    v_mov_b32 v43, 0x3b000000
    v_mfma_f32_32x32x16_bf16 v[80:95], a[228:231], v[240:243], v[80:95]
    v_fma_f32 v42, v41, v43, -v42
    v_max_f32 v42, 0, v42
    v_add_f32 v42, 0x3727c5ac, v42
    buffer_load_dword v114, v113, s[20:23], 0 offen
    v_add_u32 v113, 229376, v113
    ds_read_b64_tr_b16 a[224:225], v2 offset:512
    ds_read_b64_tr_b16 a[226:227], v2 offset:4096
    ds_read_b64_tr_b16 a[228:229], v2 offset:1408
    ds_read_b64_tr_b16 a[230:231], v2 offset:4992
    s_waitcnt vmcnt(11)
    s_waitcnt lgkmcnt(12)
    v_mfma_f32_32x32x16_bf16 v[64:79], a[232:235], v[244:247], v[64:79]
    v_rsq_f32 v43, v42
    v_sqrt_f32 v30, v42
    v_mul_f32 v28, 0xc0135761, v43
    v_mfma_f32_32x32x16_bf16 v[80:95], a[236:239], v[244:247], v[80:95]
    v_mul_f32 v42, v43, v43
    v_mul_f32 v42, 0x3d372713, v42
    v_mul_f32 v29, v28, v42
    ds_read_b64_tr_b16 a[232:233], v2 offset:2304
    ds_read_b64_tr_b16 a[234:235], v2 offset:5888
    ds_read_b64_tr_b16 a[236:237], v2 offset:3200
    ds_read_b64_tr_b16 a[238:239], v2 offset:6784
    s_waitcnt vmcnt(10)
    s_waitcnt lgkmcnt(12)
    v_mfma_f32_32x32x16_bf16 v[64:79], a[240:243], v[248:251], v[64:79]
    v_cvt_pk_bf16_f32 v40, v31, v31
    v_and_b32 v40, 0xffff0000, v40
    v_sub_f32 v40, v31, v40
    v_mfma_f32_32x32x16_bf16 v[80:95], a[244:247], v[248:251], v[80:95]
    v_cvt_pk_bf16_f32 v40, v31, v40
    v_cmp_gt_u32 vcc, 32, v0
    s_nop 1
    v_cndmask_b32 v120, 0, v40, vcc
    ds_read_b64_tr_b16 a[240:241], v4 offset:0
    ds_read_b64_tr_b16 a[242:243], v4 offset:3584
    ds_read_b64_tr_b16 a[244:245], v2 offset:14848
    ds_read_b64_tr_b16 a[246:247], v2 offset:18432
    s_waitcnt vmcnt(9)
    s_waitcnt lgkmcnt(12)
    v_mfma_f32_32x32x16_bf16 v[64:79], a[248:251], v[252:255], v[64:79]
    v_mov_b32 v121, v120
    v_mov_b32 v26, v120
    s_nop 1
    v_permlane16_swap_b32 v26, v22
    v_mfma_f32_32x32x16_bf16 v[80:95], a[252:255], v[252:255], v[80:95]
    v_mov_b32 v27, v26
    v_mov_b32 v23, v22
    v_mfma_f32_32x32x16_bf16 v[64:79], v[12:15], v[120:123], v[64:79]
    v_mfma_f32_32x32x16_bf16 v[80:95], v[14:17], v[120:123], v[80:95]
    s_nop 10
    v_pk_mul_f32 v[40:41], v[64:65], v[64:65]
    v_pk_mul_f32 v[42:43], v[66:67], v[66:67]
    v_pk_fma_f32 v[40:41], v[40:41], v[28:29], v[28:29] op_sel:[0,1,0] op_sel_hi:[1,1,0]
    v_pk_fma_f32 v[42:43], v[42:43], v[28:29], v[28:29] op_sel:[0,1,0] op_sel_hi:[1,1,0]
    v_pk_mul_f32 v[40:41], v[64:65], v[40:41]
    s_waitcnt vmcnt(5)
    ds_read_b64_tr_b16 a[56:57], v8 offset:0
    ds_read_b64_tr_b16 a[60:61], v9 offset:0
    ds_read_b64_tr_b16 a[58:59], v8 offset:1024
    ds_read_b64_tr_b16 a[62:63], v9 offset:1024
    v_pk_mul_f32 v[42:43], v[66:67], v[42:43]
    v_exp_f32_e64 v40, v40
    v_exp_f32_e64 v41, v41
    v_exp_f32_e64 v42, v42
    v_exp_f32_e64 v43, v43
    ds_read_b64_tr_b16 a[64:65], v8 offset:2048
    ds_read_b64_tr_b16 a[68:69], v9 offset:2048
    ds_read_b64_tr_b16 a[66:67], v8 offset:3072
    ds_read_b64_tr_b16 a[70:71], v9 offset:3072
    v_pk_fma_f32 v[40:41], v[40:41], v[30:31], v[30:31] op_sel:[0,0,0] op_sel_hi:[1,0,0]
    v_pk_fma_f32 v[42:43], v[42:43], v[30:31], v[30:31] op_sel:[0,0,0] op_sel_hi:[1,0,0]
    v_rcp_f32_e64 v40, v40
    v_rcp_f32_e64 v41, v41
    v_rcp_f32_e64 v42, v42
    v_rcp_f32_e64 v43, v43
    v_pk_mul_f32 v[40:41], v[64:65], v[40:41]
    v_pk_mul_f32 v[42:43], v[66:67], v[42:43]
    v_cvt_pk_bf16_f32 v48, v40, v41
    v_cvt_pk_bf16_f32 v49, v42, v43
    s_waitcnt lgkmcnt(0)
    s_add_u32 m0, s64, 0
    s_lshl4_add_u32 s76, s78, 3072
    buffer_load_dwordx4 v7, s[20:23], s76 offen offset:0 lds
    v_pk_mul_f32 v[44:45], v[68:69], v[68:69]
    v_pk_mul_f32 v[46:47], v[70:71], v[70:71]
    v_pk_fma_f32 v[44:45], v[44:45], v[28:29], v[28:29] op_sel:[0,1,0] op_sel_hi:[1,1,0]
    v_pk_fma_f32 v[46:47], v[46:47], v[28:29], v[28:29] op_sel:[0,1,0] op_sel_hi:[1,1,0]
    v_pk_mul_f32 v[44:45], v[68:69], v[44:45]
    buffer_load_dwordx4 v57, s[20:23], s76 offen offset:1024 lds
    v_pk_mul_f32 v[46:47], v[70:71], v[46:47]
    v_exp_f32_e64 v44, v44
    v_exp_f32_e64 v45, v45
    v_exp_f32_e64 v46, v46
    v_exp_f32_e64 v47, v47
    buffer_load_dwordx4 v58, s[20:23], s76 offen offset:2048 lds
    v_pk_fma_f32 v[44:45], v[44:45], v[30:31], v[30:31] op_sel:[0,0,0] op_sel_hi:[1,0,0]
    v_pk_fma_f32 v[46:47], v[46:47], v[30:31], v[30:31] op_sel:[0,0,0] op_sel_hi:[1,0,0]
    v_rcp_f32_e64 v44, v44
    v_rcp_f32_e64 v45, v45
    v_rcp_f32_e64 v46, v46
    buffer_load_dwordx4 v59, s[20:23], s76 offen offset:3072 lds
    v_rcp_f32_e64 v47, v47
    v_pk_mul_f32 v[44:45], v[68:69], v[44:45]
    v_pk_mul_f32 v[46:47], v[70:71], v[46:47]
    v_cvt_pk_bf16_f32 v50, v44, v45
    v_cvt_pk_bf16_f32 v51, v46, v47
    v_pk_mul_f32 v[40:41], v[72:73], v[72:73]
    v_pk_mul_f32 v[42:43], v[74:75], v[74:75]
    v_pk_fma_f32 v[40:41], v[40:41], v[28:29], v[28:29] op_sel:[0,1,0] op_sel_hi:[1,1,0]
    v_pk_fma_f32 v[42:43], v[42:43], v[28:29], v[28:29] op_sel:[0,1,0] op_sel_hi:[1,1,0]
    v_pk_mul_f32 v[40:41], v[72:73], v[40:41]
    v_pk_mul_f32 v[42:43], v[74:75], v[42:43]
    v_exp_f32_e64 v40, v40
    v_exp_f32_e64 v41, v41
    v_exp_f32_e64 v42, v42
    v_exp_f32_e64 v43, v43
    v_pk_fma_f32 v[40:41], v[40:41], v[30:31], v[30:31] op_sel:[0,0,0] op_sel_hi:[1,0,0]
    v_pk_fma_f32 v[42:43], v[42:43], v[30:31], v[30:31] op_sel:[0,0,0] op_sel_hi:[1,0,0]
    v_rcp_f32_e64 v40, v40
    v_rcp_f32_e64 v41, v41
    v_rcp_f32_e64 v42, v42
    v_rcp_f32_e64 v43, v43
    v_pk_mul_f32 v[40:41], v[72:73], v[40:41]
    v_pk_mul_f32 v[42:43], v[74:75], v[42:43]
    v_cvt_pk_bf16_f32 v52, v40, v41
    v_cvt_pk_bf16_f32 v53, v42, v43
    v_pk_mul_f32 v[44:45], v[76:77], v[76:77]
    v_pk_mul_f32 v[46:47], v[78:79], v[78:79]
    v_pk_fma_f32 v[44:45], v[44:45], v[28:29], v[28:29] op_sel:[0,1,0] op_sel_hi:[1,1,0]
    v_pk_fma_f32 v[46:47], v[46:47], v[28:29], v[28:29] op_sel:[0,1,0] op_sel_hi:[1,1,0]
    v_pk_mul_f32 v[44:45], v[76:77], v[44:45]
    v_pk_mul_f32 v[46:47], v[78:79], v[46:47]
    v_exp_f32_e64 v44, v44
    v_exp_f32_e64 v45, v45
    v_exp_f32_e64 v46, v46
    v_exp_f32_e64 v47, v47
    v_pk_fma_f32 v[44:45], v[44:45], v[30:31], v[30:31] op_sel:[0,0,0] op_sel_hi:[1,0,0]
    v_pk_fma_f32 v[46:47], v[46:47], v[30:31], v[30:31] op_sel:[0,0,0] op_sel_hi:[1,0,0]
    v_rcp_f32_e64 v44, v44
    v_rcp_f32_e64 v45, v45
    v_rcp_f32_e64 v46, v46
    s_waitcnt vmcnt(5)
    ds_read_b64_tr_b16 a[72:73], v8 offset:4096
    ds_read_b64_tr_b16 a[76:77], v9 offset:4096
    ds_read_b64_tr_b16 a[74:75], v8 offset:5120
    ds_read_b64_tr_b16 a[78:79], v9 offset:5120
    v_rcp_f32_e64 v47, v47
    v_pk_mul_f32 v[44:45], v[76:77], v[44:45]
    v_pk_mul_f32 v[46:47], v[78:79], v[46:47]
    v_cvt_pk_bf16_f32 v54, v44, v45
    v_cvt_pk_bf16_f32 v55, v46, v47
    ds_read_b64_tr_b16 a[80:81], v8 offset:6144
    ds_read_b64_tr_b16 a[84:85], v9 offset:6144
    ds_read_b64_tr_b16 a[82:83], v8 offset:7168
    ds_read_b64_tr_b16 a[86:87], v9 offset:7168
    buffer_store_dwordx4 v[48:51], v1, s[28:31], s66 offen offset:0 sc1
    buffer_store_dwordx4 v[52:55], v1, s[28:31], s66 offen offset:1024 sc1
    v_pk_mul_f32 v[40:41], v[80:81], v[80:81]
    v_pk_mul_f32 v[42:43], v[82:83], v[82:83]
    v_pk_fma_f32 v[40:41], v[40:41], v[28:29], v[28:29] op_sel:[0,1,0] op_sel_hi:[1,1,0]
    v_pk_fma_f32 v[42:43], v[42:43], v[28:29], v[28:29] op_sel:[0,1,0] op_sel_hi:[1,1,0]
    v_pk_mul_f32 v[40:41], v[80:81], v[40:41]
    v_pk_mul_f32 v[42:43], v[82:83], v[42:43]
    v_exp_f32_e64 v40, v40
    v_exp_f32_e64 v41, v41
    v_exp_f32_e64 v42, v42
    v_exp_f32_e64 v43, v43
    s_waitcnt lgkmcnt(0)
    s_add_u32 m0, s64, 4096
    s_lshl4_add_u32 s76, s78, 35840
    buffer_load_dwordx4 v7, s[20:23], s76 offen offset:0 lds
    v_pk_fma_f32 v[40:41], v[40:41], v[30:31], v[30:31] op_sel:[0,0,0] op_sel_hi:[1,0,0]
    v_pk_fma_f32 v[42:43], v[42:43], v[30:31], v[30:31] op_sel:[0,0,0] op_sel_hi:[1,0,0]
    v_rcp_f32_e64 v40, v40
    v_rcp_f32_e64 v41, v41
    v_rcp_f32_e64 v42, v42
    buffer_load_dwordx4 v57, s[20:23], s76 offen offset:1024 lds
    v_rcp_f32_e64 v43, v43
    v_pk_mul_f32 v[40:41], v[80:81], v[40:41]
    v_pk_mul_f32 v[42:43], v[82:83], v[42:43]
    v_cvt_pk_bf16_f32 v32, v40, v41
    v_cvt_pk_bf16_f32 v33, v42, v43
    buffer_load_dwordx4 v58, s[20:23], s76 offen offset:2048 lds
    v_pk_mul_f32 v[44:45], v[84:85], v[84:85]
    v_pk_mul_f32 v[46:47], v[86:87], v[86:87]
    v_pk_fma_f32 v[44:45], v[44:45], v[28:29], v[28:29] op_sel:[0,1,0] op_sel_hi:[1,1,0]
    v_pk_fma_f32 v[46:47], v[46:47], v[28:29], v[28:29] op_sel:[0,1,0] op_sel_hi:[1,1,0]
    v_pk_mul_f32 v[44:45], v[84:85], v[44:45]
    buffer_load_dwordx4 v59, s[20:23], s76 offen offset:3072 lds
    v_pk_mul_f32 v[46:47], v[86:87], v[46:47]
    v_exp_f32_e64 v44, v44
    v_exp_f32_e64 v45, v45
    v_exp_f32_e64 v46, v46
    v_exp_f32_e64 v47, v47
    v_pk_fma_f32 v[44:45], v[44:45], v[30:31], v[30:31] op_sel:[0,0,0] op_sel_hi:[1,0,0]
    v_pk_fma_f32 v[46:47], v[46:47], v[30:31], v[30:31] op_sel:[0,0,0] op_sel_hi:[1,0,0]
    v_rcp_f32_e64 v44, v44
    v_rcp_f32_e64 v45, v45
    v_rcp_f32_e64 v46, v46
    v_rcp_f32_e64 v47, v47
    v_pk_mul_f32 v[44:45], v[84:85], v[44:45]
    v_pk_mul_f32 v[46:47], v[86:87], v[46:47]
    v_cvt_pk_bf16_f32 v34, v44, v45
    v_cvt_pk_bf16_f32 v35, v46, v47
    v_pk_mul_f32 v[40:41], v[88:89], v[88:89]
    v_pk_mul_f32 v[42:43], v[90:91], v[90:91]
    v_pk_fma_f32 v[40:41], v[40:41], v[28:29], v[28:29] op_sel:[0,1,0] op_sel_hi:[1,1,0]
    v_pk_fma_f32 v[42:43], v[42:43], v[28:29], v[28:29] op_sel:[0,1,0] op_sel_hi:[1,1,0]
    v_pk_mul_f32 v[40:41], v[88:89], v[40:41]
    v_pk_mul_f32 v[42:43], v[90:91], v[42:43]
    v_exp_f32_e64 v40, v40
    v_exp_f32_e64 v41, v41
    v_exp_f32_e64 v42, v42
    v_exp_f32_e64 v43, v43
    v_pk_fma_f32 v[40:41], v[40:41], v[30:31], v[30:31] op_sel:[0,0,0] op_sel_hi:[1,0,0]
    v_pk_fma_f32 v[42:43], v[42:43], v[30:31], v[30:31] op_sel:[0,0,0] op_sel_hi:[1,0,0]
    v_rcp_f32_e64 v40, v40
    v_rcp_f32_e64 v41, v41
    v_rcp_f32_e64 v42, v42
    v_rcp_f32_e64 v43, v43
    v_pk_mul_f32 v[40:41], v[88:89], v[40:41]
    v_pk_mul_f32 v[42:43], v[90:91], v[42:43]
    v_cvt_pk_bf16_f32 v36, v40, v41
    v_cvt_pk_bf16_f32 v37, v42, v43
    v_pk_mul_f32 v[44:45], v[92:93], v[92:93]
    v_pk_mul_f32 v[46:47], v[94:95], v[94:95]
    v_pk_fma_f32 v[44:45], v[44:45], v[28:29], v[28:29] op_sel:[0,1,0] op_sel_hi:[1,1,0]
    v_pk_fma_f32 v[46:47], v[46:47], v[28:29], v[28:29] op_sel:[0,1,0] op_sel_hi:[1,1,0]
    v_pk_mul_f32 v[44:45], v[92:93], v[44:45]
    v_pk_mul_f32 v[46:47], v[94:95], v[46:47]
    v_exp_f32_e64 v44, v44
    v_exp_f32_e64 v45, v45
    v_exp_f32_e64 v46, v46
    v_exp_f32_e64 v47, v47
    v_pk_fma_f32 v[44:45], v[44:45], v[30:31], v[30:31] op_sel:[0,0,0] op_sel_hi:[1,0,0]
    v_pk_fma_f32 v[46:47], v[46:47], v[30:31], v[30:31] op_sel:[0,0,0] op_sel_hi:[1,0,0]
    v_rcp_f32_e64 v44, v44
    v_rcp_f32_e64 v45, v45
    v_rcp_f32_e64 v46, v46
    v_rcp_f32_e64 v47, v47
    v_pk_mul_f32 v[44:45], v[92:93], v[44:45]
    v_pk_mul_f32 v[46:47], v[94:95], v[46:47]
    v_cvt_pk_bf16_f32 v38, v44, v45
    v_cvt_pk_bf16_f32 v39, v46, v47
    buffer_store_dwordx4 v[32:35], v1, s[28:31], s66 offen offset:2048 sc1
    buffer_store_dwordx4 v[36:39], v1, s[28:31], s66 offen offset:3072 sc1
    ds_read_b64_tr_b16 a[248:249], v2 offset:15744
    ds_read_b64_tr_b16 a[250:251], v2 offset:19328
    v_mfma_f32_32x32x16_bf16 v[96:111], a[224:227], v[128:131], 0
    ds_read_b64_tr_b16 a[252:253], v4 offset:1792
    ds_read_b64_tr_b16 a[254:255], v4 offset:5376
    v_mfma_f32_32x32x16_bf16 v[96:111], a[228:231], v[132:135], v[96:111]
    ds_read_b64_tr_b16 a[224:225], v2 offset:16640
    ds_read_b64_tr_b16 a[226:227], v2 offset:20224
    v_mfma_f32_32x32x16_bf16 v[96:111], a[232:235], v[136:139], v[96:111]
    v_permlane16_swap_b32 v128, v132
    v_permlane16_swap_b32 v129, v133
    v_permlane16_swap_b32 v130, v134
    v_permlane16_swap_b32 v131, v135
    ds_read_b64_tr_b16 a[228:229], v2 offset:17536
    ds_read_b64_tr_b16 a[230:231], v2 offset:21120
    v_mfma_f32_32x32x16_bf16 v[96:111], a[236:239], v[140:143], v[96:111]
    s_waitcnt vmcnt(8)
    ds_read_b64_tr_b16 a[112:113], v8 offset:0
    ds_read_b64_tr_b16 a[116:117], v9 offset:0
    ds_read_b64_tr_b16 a[114:115], v8 offset:1024
    ds_read_b64_tr_b16 a[118:119], v9 offset:1024
    ds_read_b64_tr_b16 a[232:233], v4 offset:14336
    ds_read_b64_tr_b16 a[234:235], v4 offset:17920
    v_mfma_f32_16x16x32_bf16 v[112:115], a[240:243], v[128:131], 0
    v_mfma_f32_16x16x32_bf16 v[116:119], a[240:243], v[132:135], 0
    ds_read_b64_tr_b16 a[120:121], v8 offset:2048
    ds_read_b64_tr_b16 a[124:125], v9 offset:2048
    ds_read_b64_tr_b16 a[122:123], v8 offset:3072
    ds_read_b64_tr_b16 a[126:127], v9 offset:3072
    ds_read_b64_tr_b16 a[236:237], v2 offset:29184
    ds_read_b64_tr_b16 a[238:239], v2 offset:32768
    v_mfma_f32_32x32x16_bf16 v[96:111], a[244:247], v[144:147], v[96:111]
    v_permlane16_swap_b32 v136, v140
    v_permlane16_swap_b32 v137, v141
    v_permlane16_swap_b32 v138, v142
    v_permlane16_swap_b32 v139, v143
    ds_read_b64_tr_b16 a[240:241], v2 offset:30080
    ds_read_b64_tr_b16 a[242:243], v2 offset:33664
    s_waitcnt lgkmcnt(15)
    v_mfma_f32_32x32x16_bf16 v[96:111], a[248:251], v[148:151], v[96:111]
    s_waitcnt lgkmcnt(4)
    s_add_u32 m0, s64, 0
    s_lshl4_add_u32 s76, s79, 3072
    buffer_load_dwordx4 v7, s[20:23], s76 offen offset:0 lds
    ds_read_b64_tr_b16 a[244:245], v4 offset:16128
    ds_read_b64_tr_b16 a[246:247], v4 offset:19712
    v_mfma_f32_16x16x32_bf16 v[112:115], a[252:255], v[136:139], v[112:115]
    v_mfma_f32_16x16x32_bf16 v[116:119], a[252:255], v[140:143], v[116:119]
    buffer_load_dwordx4 v57, s[20:23], s76 offen offset:1024 lds
    ds_read_b64_tr_b16 a[248:249], v2 offset:30976
    ds_read_b64_tr_b16 a[250:251], v2 offset:34560
    v_mfma_f32_32x32x16_bf16 v[96:111], a[224:227], v[152:155], v[96:111]
    v_permlane16_swap_b32 v144, v148
    v_permlane16_swap_b32 v145, v149
    v_permlane16_swap_b32 v146, v150
    v_permlane16_swap_b32 v147, v151
    buffer_load_dwordx4 v58, s[20:23], s76 offen offset:2048 lds
    ds_read_b64_tr_b16 a[252:253], v2 offset:31872
    ds_read_b64_tr_b16 a[254:255], v2 offset:35456
    v_mfma_f32_32x32x16_bf16 v[96:111], a[228:231], v[156:159], v[96:111]
    buffer_load_dwordx4 v59, s[20:23], s76 offen offset:3072 lds
    ds_read_b64_tr_b16 a[224:225], v4 offset:28672
    ds_read_b64_tr_b16 a[226:227], v4 offset:32256
    v_mfma_f32_16x16x32_bf16 v[112:115], a[232:235], v[144:147], v[112:115]
    v_mfma_f32_16x16x32_bf16 v[116:119], a[232:235], v[148:151], v[116:119]
    ds_read_b64_tr_b16 a[228:229], v2 offset:43520
    ds_read_b64_tr_b16 a[230:231], v2 offset:47104
    s_waitcnt lgkmcnt(12)
    v_mfma_f32_32x32x16_bf16 v[96:111], a[236:239], v[160:163], v[96:111]
    v_permlane16_swap_b32 v152, v156
    v_permlane16_swap_b32 v153, v157
    v_permlane16_swap_b32 v154, v158
    v_permlane16_swap_b32 v155, v159
    s_waitcnt vmcnt(6)
    ds_read_b64_tr_b16 a[128:129], v8 offset:4096
    ds_read_b64_tr_b16 a[132:133], v9 offset:4096
    ds_read_b64_tr_b16 a[130:131], v8 offset:5120
    ds_read_b64_tr_b16 a[134:135], v9 offset:5120
    ds_read_b64_tr_b16 a[232:233], v2 offset:44416
    ds_read_b64_tr_b16 a[234:235], v2 offset:48000
    s_waitcnt lgkmcnt(15)
    v_mfma_f32_32x32x16_bf16 v[96:111], a[240:243], v[164:167], v[96:111]
    ds_read_b64_tr_b16 a[136:137], v8 offset:6144
    ds_read_b64_tr_b16 a[140:141], v9 offset:6144
    ds_read_b64_tr_b16 a[138:139], v8 offset:7168
    ds_read_b64_tr_b16 a[142:143], v9 offset:7168
    ds_read_b64_tr_b16 a[236:237], v4 offset:30464
    ds_read_b64_tr_b16 a[238:239], v4 offset:34048
    s_waitcnt lgkmcnt(15)
    v_mfma_f32_16x16x32_bf16 v[112:115], a[244:247], v[152:155], v[112:115]
    v_mfma_f32_16x16x32_bf16 v[116:119], a[244:247], v[156:159], v[116:119]
    ds_read_b64_tr_b16 a[240:241], v2 offset:45312
    ds_read_b64_tr_b16 a[242:243], v2 offset:48896
    v_mfma_f32_32x32x16_bf16 v[96:111], a[248:251], v[168:171], v[96:111]
    v_permlane16_swap_b32 v160, v164
    v_permlane16_swap_b32 v161, v165
    v_permlane16_swap_b32 v162, v166
    v_permlane16_swap_b32 v163, v167
    s_waitcnt lgkmcnt(4)
    s_add_u32 m0, s64, 4096
    s_lshl4_add_u32 s76, s79, 35840
    buffer_load_dwordx4 v7, s[20:23], s76 offen offset:0 lds
    ds_read_b64_tr_b16 a[244:245], v2 offset:46208
    ds_read_b64_tr_b16 a[246:247], v2 offset:49792
    v_mfma_f32_32x32x16_bf16 v[96:111], a[252:255], v[172:175], v[96:111]
    s_waitcnt vmcnt(5)
    s_cmp_lg_u32 s57, 0
    s_nop 9
    s_cbranch_scc1 Ls_34
    s_mov_b64 exec, 255
    buffer_store_dword v10, v6, s[28:31], s63 offen
    s_branch Ld_35
Ls_34:
    s_mov_b64 exec, 1
    buffer_store_dword v10, v6, s[28:31], s63 offen sc1
Ld_35:
    s_mov_b64 exec, -1
    s_add_u32 s63, s63, 512
    ds_read_b64_tr_b16 a[248:249], v4 offset:43008
    ds_read_b64_tr_b16 a[250:251], v4 offset:46592
    v_mfma_f32_16x16x32_bf16 v[112:115], a[224:227], v[160:163], v[112:115]
    v_mfma_f32_16x16x32_bf16 v[116:119], a[224:227], v[164:167], v[116:119]
    buffer_load_dwordx4 v57, s[20:23], s76 offen offset:1024 lds
    ds_read_b64_tr_b16 a[252:253], v3 offset:512
    ds_read_b64_tr_b16 a[254:255], v3 offset:4096
    v_mfma_f32_32x32x16_bf16 v[96:111], a[228:231], v[176:179], v[96:111]
    v_permlane16_swap_b32 v168, v172
    v_permlane16_swap_b32 v169, v173
    v_permlane16_swap_b32 v170, v174
    v_permlane16_swap_b32 v171, v175
    buffer_load_dwordx4 v58, s[20:23], s76 offen offset:2048 lds
    ds_read_b64_tr_b16 a[224:225], v3 offset:1408
    ds_read_b64_tr_b16 a[226:227], v3 offset:4992
    v_mfma_f32_32x32x16_bf16 v[96:111], a[232:235], v[180:183], v[96:111]
    buffer_load_dwordx4 v59, s[20:23], s76 offen offset:3072 lds
    ds_read_b64_tr_b16 a[228:229], v4 offset:44800
    ds_read_b64_tr_b16 a[230:231], v4 offset:48384
    s_waitcnt lgkmcnt(12)
    v_mfma_f32_16x16x32_bf16 v[112:115], a[236:239], v[168:171], v[112:115]
    v_mfma_f32_16x16x32_bf16 v[116:119], a[236:239], v[172:175], v[116:119]
    ds_read_b64_tr_b16 a[232:233], v3 offset:2304
    ds_read_b64_tr_b16 a[234:235], v3 offset:5888
    s_waitcnt lgkmcnt(12)
    v_mfma_f32_32x32x16_bf16 v[96:111], a[240:243], v[184:187], v[96:111]
    v_permlane16_swap_b32 v176, v180
    v_permlane16_swap_b32 v177, v181
    v_permlane16_swap_b32 v178, v182
    v_permlane16_swap_b32 v179, v183
    s_waitcnt vmcnt(5)
    ds_read_b64_tr_b16 a[168:169], v8 offset:0
    ds_read_b64_tr_b16 a[172:173], v9 offset:0
    ds_read_b64_tr_b16 a[170:171], v8 offset:1024
    ds_read_b64_tr_b16 a[174:175], v9 offset:1024
    ds_read_b64_tr_b16 a[236:237], v3 offset:3200
    ds_read_b64_tr_b16 a[238:239], v3 offset:6784
    s_waitcnt lgkmcnt(15)
    v_mfma_f32_32x32x16_bf16 v[96:111], a[244:247], v[188:191], v[96:111]
    ds_read_b64_tr_b16 a[176:177], v8 offset:2048
    ds_read_b64_tr_b16 a[180:181], v9 offset:2048
    ds_read_b64_tr_b16 a[178:179], v8 offset:3072
    ds_read_b64_tr_b16 a[182:183], v9 offset:3072
    ds_read_b64_tr_b16 a[240:241], v5 offset:0
    ds_read_b64_tr_b16 a[242:243], v5 offset:3584
    s_waitcnt lgkmcnt(15)
    v_mfma_f32_16x16x32_bf16 v[112:115], a[248:251], v[176:179], v[112:115]
    v_mfma_f32_16x16x32_bf16 v[116:119], a[248:251], v[180:183], v[116:119]
    ds_read_b64_tr_b16 a[244:245], v3 offset:14848
    ds_read_b64_tr_b16 a[246:247], v3 offset:18432
    v_mfma_f32_32x32x16_bf16 v[96:111], a[252:255], v[192:195], v[96:111]
    v_permlane16_swap_b32 v184, v188
    v_permlane16_swap_b32 v185, v189
    v_permlane16_swap_b32 v186, v190
    v_permlane16_swap_b32 v187, v191
    s_waitcnt lgkmcnt(4)
    s_add_u32 m0, s64, 0
    s_lshl4_add_u32 s76, s73, 68608
    buffer_load_dwordx4 v7, s[20:23], s76 offen offset:0 lds
    ds_read_b64_tr_b16 a[248:249], v3 offset:15744
    ds_read_b64_tr_b16 a[250:251], v3 offset:19328
    v_mfma_f32_32x32x16_bf16 v[96:111], a[224:227], v[196:199], v[96:111]
    buffer_load_dwordx4 v57, s[20:23], s76 offen offset:1024 lds
    ds_read_b64_tr_b16 a[252:253], v5 offset:1792
    ds_read_b64_tr_b16 a[254:255], v5 offset:5376
    v_mfma_f32_16x16x32_bf16 v[112:115], a[228:231], v[184:187], v[112:115]
    v_mfma_f32_16x16x32_bf16 v[116:119], a[228:231], v[188:191], v[116:119]
    buffer_load_dwordx4 v58, s[20:23], s76 offen offset:2048 lds
    ds_read_b64_tr_b16 a[224:225], v3 offset:16640
    ds_read_b64_tr_b16 a[226:227], v3 offset:20224
    v_mfma_f32_32x32x16_bf16 v[96:111], a[232:235], v[200:203], v[96:111]
    v_permlane16_swap_b32 v192, v196
    v_permlane16_swap_b32 v193, v197
    v_permlane16_swap_b32 v194, v198
    v_permlane16_swap_b32 v195, v199
    buffer_load_dwordx4 v59, s[20:23], s76 offen offset:3072 lds
    ds_read_b64_tr_b16 a[228:229], v3 offset:17536
    ds_read_b64_tr_b16 a[230:231], v3 offset:21120
    v_mfma_f32_32x32x16_bf16 v[96:111], a[236:239], v[204:207], v[96:111]
    ds_read_b64_tr_b16 a[232:233], v5 offset:14336
    ds_read_b64_tr_b16 a[234:235], v5 offset:17920
    s_waitcnt lgkmcnt(12)
    v_mfma_f32_16x16x32_bf16 v[112:115], a[240:243], v[192:195], v[112:115]
    v_mfma_f32_16x16x32_bf16 v[116:119], a[240:243], v[196:199], v[116:119]
    s_waitcnt vmcnt(4)
    ds_read_b64_tr_b16 a[184:185], v8 offset:4096
    ds_read_b64_tr_b16 a[188:189], v9 offset:4096
    ds_read_b64_tr_b16 a[186:187], v8 offset:5120
    ds_read_b64_tr_b16 a[190:191], v9 offset:5120
    ds_read_b64_tr_b16 a[236:237], v3 offset:29184
    ds_read_b64_tr_b16 a[238:239], v3 offset:32768
    s_waitcnt lgkmcnt(15)
    v_mfma_f32_32x32x16_bf16 v[96:111], a[244:247], v[208:211], v[96:111]
    v_permlane16_swap_b32 v200, v204
    v_permlane16_swap_b32 v201, v205
    v_permlane16_swap_b32 v202, v206
    v_permlane16_swap_b32 v203, v207
    ds_read_b64_tr_b16 a[192:193], v8 offset:6144
    ds_read_b64_tr_b16 a[196:197], v9 offset:6144
    ds_read_b64_tr_b16 a[194:195], v8 offset:7168
    ds_read_b64_tr_b16 a[198:199], v9 offset:7168
    s_mov_b32 s71, s57
    s_mov_b32 s72, 0
    s_cmp_ge_u32 s71, 512
    s_nop 0
    s_cbranch_scc1 Lg_40
    s_add_u32 s70, s67, s71
    s_load_dwordx8 s[36:43], s[60:61], s70
    s_add_u32 s71, s71, 64
    s_branch Lb_39
Lg_40:
    s_load_dwordx8 s[36:43], s[60:61], s67 glc
Lb_39:
    ds_read_b64_tr_b16 a[240:241], v3 offset:30080
    ds_read_b64_tr_b16 a[242:243], v3 offset:33664
    s_waitcnt lgkmcnt(15)
    v_mfma_f32_32x32x16_bf16 v[96:111], a[248:251], v[212:215], v[96:111]
    ds_read_b64_tr_b16 a[244:245], v5 offset:16128
    ds_read_b64_tr_b16 a[246:247], v5 offset:19712
    v_mfma_f32_16x16x32_bf16 v[112:115], a[252:255], v[200:203], v[112:115]
    v_mfma_f32_16x16x32_bf16 v[116:119], a[252:255], v[204:207], v[116:119]
    s_waitcnt lgkmcnt(4)
    s_add_u32 m0, s64, 4096
    s_lshl4_add_u32 s76, s74, 68608
    buffer_load_dwordx4 v7, s[20:23], s76 offen offset:0 lds
    ds_read_b64_tr_b16 a[248:249], v3 offset:30976
    ds_read_b64_tr_b16 a[250:251], v3 offset:34560
    v_mfma_f32_32x32x16_bf16 v[96:111], a[224:227], v[216:219], v[96:111]
    v_permlane16_swap_b32 v208, v212
    v_permlane16_swap_b32 v209, v213
    v_permlane16_swap_b32 v210, v214
    v_permlane16_swap_b32 v211, v215
    buffer_load_dwordx4 v57, s[20:23], s76 offen offset:1024 lds
    ds_read_b64_tr_b16 a[252:253], v3 offset:31872
    ds_read_b64_tr_b16 a[254:255], v3 offset:35456
    v_mfma_f32_32x32x16_bf16 v[96:111], a[228:231], v[220:223], v[96:111]
    buffer_load_dwordx4 v58, s[20:23], s76 offen offset:2048 lds
    s_nop 10
    s_branch Lw_37
Lp_36:
    s_add_u32 s72, s72, 1
    s_cmp_gt_u32 s72, 30000
    s_cbranch_scc1 L_end
    s_cmp_ge_u32 s71, 512
    s_cbranch_scc1 Lg_41
    s_add_u32 s70, s67, s71
    s_load_dwordx8 s[36:43], s[60:61], s70
    s_add_u32 s71, s71, 64
    s_branch Lw_37
Lg_41:
    s_load_dwordx8 s[36:43], s[60:61], s67 glc
Lw_37:
    s_waitcnt lgkmcnt(0)
    s_and_b64 s[36:37], s[36:37], s[40:41]
    s_and_b64 s[38:39], s[38:39], s[42:43]
    s_and_b64 s[36:37], s[36:37], s[38:39]
    s_and_b32 s36, s36, s37
    s_cbranch_scc0 Lp_36
    s_add_u32 s67, s67, 512
    ds_read_b64_tr_b16 a[224:225], v5 offset:28672
    ds_read_b64_tr_b16 a[226:227], v5 offset:32256
    v_mfma_f32_16x16x32_bf16 v[112:115], a[232:235], v[208:211], v[112:115]
    v_mfma_f32_16x16x32_bf16 v[116:119], a[232:235], v[212:215], v[116:119]
    buffer_load_dwordx4 v59, s[20:23], s76 offen offset:3072 lds
    buffer_load_dwordx4 v[128:131], v11, s[28:31], s4 offen offset:0 sc1
    ds_read_b64_tr_b16 a[228:229], v3 offset:43520
    ds_read_b64_tr_b16 a[230:231], v3 offset:47104
    v_mfma_f32_32x32x16_bf16 v[96:111], a[236:239], v[224:227], v[96:111]
    v_permlane16_swap_b32 v216, v220
    v_permlane16_swap_b32 v217, v221
    v_permlane16_swap_b32 v218, v222
    v_permlane16_swap_b32 v219, v223
    buffer_load_dwordx4 v[132:135], v56, s[28:31], s4 offen offset:0 sc1
    ds_read_b64_tr_b16 a[232:233], v3 offset:44416
    ds_read_b64_tr_b16 a[234:235], v3 offset:48000
    v_mfma_f32_32x32x16_bf16 v[96:111], a[240:243], v[228:231], v[96:111]
    s_waitcnt vmcnt(6)
    ds_read_b64_tr_b16 a[40:41], v8 offset:0
    ds_read_b64_tr_b16 a[44:45], v9 offset:0
    ds_read_b64_tr_b16 a[42:43], v8 offset:1024
    ds_read_b64_tr_b16 a[46:47], v9 offset:1024
    buffer_load_dwordx4 v[136:139], v11, s[28:31], s4 offen offset:1024 sc1
    ds_read_b64_tr_b16 a[236:237], v5 offset:30464
    ds_read_b64_tr_b16 a[238:239], v5 offset:34048
    v_mfma_f32_16x16x32_bf16 v[112:115], a[244:247], v[216:219], v[112:115]
    v_mfma_f32_16x16x32_bf16 v[116:119], a[244:247], v[220:223], v[116:119]
    ds_read_b64_tr_b16 a[48:49], v8 offset:2048
    ds_read_b64_tr_b16 a[52:53], v9 offset:2048
    ds_read_b64_tr_b16 a[50:51], v8 offset:3072
    ds_read_b64_tr_b16 a[54:55], v9 offset:3072
    buffer_load_dwordx4 v[140:143], v56, s[28:31], s4 offen offset:1024 sc1
    ds_read_b64_tr_b16 a[240:241], v3 offset:45312
    ds_read_b64_tr_b16 a[242:243], v3 offset:48896
    v_mfma_f32_32x32x16_bf16 v[96:111], a[248:251], v[232:235], v[96:111]
    v_permlane16_swap_b32 v224, v228
    v_permlane16_swap_b32 v225, v229
    v_permlane16_swap_b32 v226, v230
    v_permlane16_swap_b32 v227, v231
    buffer_load_dwordx4 v[144:147], v11, s[28:31], s4 offen offset:2048 sc1
    ds_read_b64_tr_b16 a[244:245], v3 offset:46208
    ds_read_b64_tr_b16 a[246:247], v3 offset:49792
    v_mfma_f32_32x32x16_bf16 v[96:111], a[252:255], v[236:239], v[96:111]
    s_waitcnt lgkmcnt(4)
    s_add_u32 m0, s64, 0
    s_add_u32 s76, s73, s80
    s_lshl4_add_u32 s76, s76, 3072
    buffer_load_dwordx4 v7, s[20:23], s76 offen offset:0 lds
    buffer_load_dwordx4 v[148:151], v56, s[28:31], s4 offen offset:2048 sc1
    ds_read_b64_tr_b16 a[248:249], v5 offset:43008
    ds_read_b64_tr_b16 a[250:251], v5 offset:46592
    v_mfma_f32_16x16x32_bf16 v[112:115], a[224:227], v[224:227], v[112:115]
    v_mfma_f32_16x16x32_bf16 v[116:119], a[224:227], v[228:231], v[116:119]
    buffer_load_dwordx4 v57, s[20:23], s76 offen offset:1024 lds
    buffer_load_dwordx4 v[152:155], v11, s[28:31], s4 offen offset:3072 sc1
    ds_read_b64_tr_b16 a[252:253], v5 offset:44800
    ds_read_b64_tr_b16 a[254:255], v5 offset:48384
    v_mfma_f32_32x32x16_bf16 v[96:111], a[228:231], v[240:243], v[96:111]
    v_permlane16_swap_b32 v232, v236
    v_permlane16_swap_b32 v233, v237
    v_permlane16_swap_b32 v234, v238
    v_permlane16_swap_b32 v235, v239
    s_add_u32 s76, s74, s81
    s_lshl4_add_u32 s76, s76, 4294953984
    buffer_load_dwordx4 v58, s[20:23], s76 offen offset:2048 lds
    buffer_load_dwordx4 v[156:159], v56, s[28:31], s4 offen offset:3072 sc1
    v_mfma_f32_32x32x16_bf16 v[96:111], a[232:235], v[244:247], v[96:111]
    buffer_load_dwordx4 v59, s[20:23], s76 offen offset:3072 lds
    buffer_load_dwordx4 v[160:163], v11, s[28:31], s5 offen offset:0 sc1
    v_mfma_f32_16x16x32_bf16 v[112:115], a[236:239], v[232:235], v[112:115]
    v_mfma_f32_16x16x32_bf16 v[116:119], a[236:239], v[236:239], v[116:119]
    buffer_load_dwordx4 v[164:167], v56, s[28:31], s5 offen offset:0 sc1
    s_waitcnt lgkmcnt(6)
    v_mfma_f32_32x32x16_bf16 v[96:111], a[240:243], v[248:251], v[96:111]
    v_permlane16_swap_b32 v240, v244
    v_permlane16_swap_b32 v241, v245
    v_permlane16_swap_b32 v242, v246
    v_permlane16_swap_b32 v243, v247
    s_waitcnt vmcnt(14)
    ds_read_b64_tr_b16 a[96:97], v8 offset:4096
    ds_read_b64_tr_b16 a[100:101], v9 offset:4096
    ds_read_b64_tr_b16 a[98:99], v8 offset:5120
    ds_read_b64_tr_b16 a[102:103], v9 offset:5120
    buffer_load_dwordx4 v[168:171], v11, s[28:31], s5 offen offset:1024 sc1
    s_waitcnt lgkmcnt(8)
    v_mfma_f32_32x32x16_bf16 v[96:111], a[244:247], v[252:255], v[96:111]
    ds_read_b64_tr_b16 a[104:105], v8 offset:6144
    ds_read_b64_tr_b16 a[108:109], v9 offset:6144
    ds_read_b64_tr_b16 a[106:107], v8 offset:7168
    ds_read_b64_tr_b16 a[110:111], v9 offset:7168
    buffer_load_dwordx4 v[172:175], v56, s[28:31], s5 offen offset:1024 sc1
    s_waitcnt lgkmcnt(10)
    v_mfma_f32_16x16x32_bf16 v[112:115], a[248:251], v[240:243], v[112:115]
    v_mfma_f32_16x16x32_bf16 v[116:119], a[248:251], v[244:247], v[116:119]
    v_mfma_f32_32x32x16_bf16 v[96:111], v[16:19], v[120:123], v[96:111]
    v_permlane16_swap_b32 v248, v252
    v_permlane16_swap_b32 v249, v253
    v_permlane16_swap_b32 v250, v254
    v_permlane16_swap_b32 v251, v255
    s_waitcnt lgkmcnt(8)
    s_nop 0
    v_mfma_f32_16x16x32_bf16 v[112:115], a[252:255], v[248:251], v[112:115]
    v_mfma_f32_16x16x32_bf16 v[116:119], a[252:255], v[252:255], v[116:119]
    s_waitcnt lgkmcnt(0)
    s_add_u32 m0, s64, 4096
    s_lshl4_add_u32 s76, s78, 68608
    buffer_load_dwordx4 v7, s[20:23], s76 offen offset:0 lds
    v_mfma_f32_16x16x32_bf16 v[112:115], v[16:19], v[24:27], v[112:115]
    v_mfma_f32_16x16x32_bf16 v[116:119], v[18:21], v[22:25], v[116:119]
    buffer_load_dwordx4 v57, s[20:23], s76 offen offset:1024 lds
    buffer_load_dwordx4 v58, s[20:23], s76 offen offset:2048 lds
    buffer_load_dwordx4 v59, s[20:23], s76 offen offset:3072 lds
    v_and_b32 v60, 31, v0
    v_bfe_u32 v61, v0, 1, 3
    v_lshrrev_b32 v62, 5, v0
    s_and_b32 s69, s3, 1
    s_lshl_b32 s69, s69, 2
    v_xor_b32 v61, s69, v61
    s_lshr_b32 s69, s3, 1
    s_lshl_b32 s69, s69, 12
    s_add_u32 s69, s69, 114688
    v_lshl_add_u32 v60, v60, 7, s69
    v_lshl_add_u32 v60, v61, 4, v60
    v_lshl_add_u32 v60, v62, 3, v60
    v_xor_b32 v61, 16, v60
    v_xor_b32 v62, 32, v60
    v_xor_b32 v63, 48, v60
    ds_read_b64 v[80:81], v60
    ds_read_b64 v[82:83], v61
    ds_read_b64 v[84:85], v62
    ds_read_b64 v[86:87], v63
    v_pk_mul_f32 v[40:41], v[96:97], v[96:97]
    v_pk_mul_f32 v[42:43], v[98:99], v[98:99]
    v_pk_fma_f32 v[40:41], v[40:41], v[28:29], v[28:29] op_sel:[0,1,0] op_sel_hi:[1,1,0]
    v_pk_fma_f32 v[42:43], v[42:43], v[28:29], v[28:29] op_sel:[0,1,0] op_sel_hi:[1,1,0]
    v_pk_mul_f32 v[40:41], v[96:97], v[40:41]
    v_pk_mul_f32 v[42:43], v[98:99], v[42:43]
    v_exp_f32_e64 v40, v40
    v_exp_f32_e64 v41, v41
    v_exp_f32_e64 v42, v42
    v_exp_f32_e64 v43, v43
    v_pk_fma_f32 v[40:41], v[40:41], v[30:31], v[30:31] op_sel:[0,0,0] op_sel_hi:[1,0,0]
    v_pk_fma_f32 v[42:43], v[42:43], v[30:31], v[30:31] op_sel:[0,0,0] op_sel_hi:[1,0,0]
    v_rcp_f32_e64 v40, v40
    v_rcp_f32_e64 v41, v41
    v_rcp_f32_e64 v42, v42
    v_rcp_f32_e64 v43, v43
    v_pk_mul_f32 v[40:41], v[96:97], v[40:41]
    v_pk_mul_f32 v[42:43], v[98:99], v[42:43]
    v_cvt_pk_bf16_f32 v48, v40, v41
    v_cvt_pk_bf16_f32 v49, v42, v43
    v_pk_mul_f32 v[44:45], v[100:101], v[100:101]
    v_pk_mul_f32 v[46:47], v[102:103], v[102:103]
    v_pk_fma_f32 v[44:45], v[44:45], v[28:29], v[28:29] op_sel:[0,1,0] op_sel_hi:[1,1,0]
    v_pk_fma_f32 v[46:47], v[46:47], v[28:29], v[28:29] op_sel:[0,1,0] op_sel_hi:[1,1,0]
    v_pk_mul_f32 v[44:45], v[100:101], v[44:45]
    v_pk_mul_f32 v[46:47], v[102:103], v[46:47]
    v_exp_f32_e64 v44, v44
    v_exp_f32_e64 v45, v45
    v_exp_f32_e64 v46, v46
    v_exp_f32_e64 v47, v47
    v_pk_fma_f32 v[44:45], v[44:45], v[30:31], v[30:31] op_sel:[0,0,0] op_sel_hi:[1,0,0]
    v_pk_fma_f32 v[46:47], v[46:47], v[30:31], v[30:31] op_sel:[0,0,0] op_sel_hi:[1,0,0]
    v_rcp_f32_e64 v44, v44
    v_rcp_f32_e64 v45, v45
    v_rcp_f32_e64 v46, v46
    v_rcp_f32_e64 v47, v47
    v_pk_mul_f32 v[44:45], v[100:101], v[44:45]
    v_pk_mul_f32 v[46:47], v[102:103], v[46:47]
    v_cvt_pk_bf16_f32 v50, v44, v45
    v_cvt_pk_bf16_f32 v51, v46, v47
    v_pk_mul_f32 v[40:41], v[104:105], v[104:105]
    v_pk_mul_f32 v[42:43], v[106:107], v[106:107]
    v_pk_fma_f32 v[40:41], v[40:41], v[28:29], v[28:29] op_sel:[0,1,0] op_sel_hi:[1,1,0]
    v_pk_fma_f32 v[42:43], v[42:43], v[28:29], v[28:29] op_sel:[0,1,0] op_sel_hi:[1,1,0]
    v_pk_mul_f32 v[40:41], v[104:105], v[40:41]
    v_pk_mul_f32 v[42:43], v[106:107], v[42:43]
    v_exp_f32_e64 v40, v40
    v_exp_f32_e64 v41, v41
    v_exp_f32_e64 v42, v42
    v_exp_f32_e64 v43, v43
    v_pk_fma_f32 v[40:41], v[40:41], v[30:31], v[30:31] op_sel:[0,0,0] op_sel_hi:[1,0,0]
    v_pk_fma_f32 v[42:43], v[42:43], v[30:31], v[30:31] op_sel:[0,0,0] op_sel_hi:[1,0,0]
    v_rcp_f32_e64 v40, v40
    v_rcp_f32_e64 v41, v41
    v_rcp_f32_e64 v42, v42
    v_rcp_f32_e64 v43, v43
    v_pk_mul_f32 v[40:41], v[104:105], v[40:41]
    v_pk_mul_f32 v[42:43], v[106:107], v[42:43]
    v_cvt_pk_bf16_f32 v52, v40, v41
    v_cvt_pk_bf16_f32 v53, v42, v43
    v_pk_mul_f32 v[44:45], v[108:109], v[108:109]
    v_pk_mul_f32 v[46:47], v[110:111], v[110:111]
    v_pk_fma_f32 v[44:45], v[44:45], v[28:29], v[28:29] op_sel:[0,1,0] op_sel_hi:[1,1,0]
    v_pk_fma_f32 v[46:47], v[46:47], v[28:29], v[28:29] op_sel:[0,1,0] op_sel_hi:[1,1,0]
    v_pk_mul_f32 v[44:45], v[108:109], v[44:45]
    v_pk_mul_f32 v[46:47], v[110:111], v[46:47]
    v_exp_f32_e64 v44, v44
    v_exp_f32_e64 v45, v45
    v_exp_f32_e64 v46, v46
    v_exp_f32_e64 v47, v47
    v_pk_fma_f32 v[44:45], v[44:45], v[30:31], v[30:31] op_sel:[0,0,0] op_sel_hi:[1,0,0]
    v_pk_fma_f32 v[46:47], v[46:47], v[30:31], v[30:31] op_sel:[0,0,0] op_sel_hi:[1,0,0]
    v_rcp_f32_e64 v44, v44
    v_rcp_f32_e64 v45, v45
    v_rcp_f32_e64 v46, v46
    v_rcp_f32_e64 v47, v47
    v_pk_mul_f32 v[44:45], v[108:109], v[44:45]
    v_pk_mul_f32 v[46:47], v[110:111], v[46:47]
    v_cvt_pk_bf16_f32 v54, v44, v45
    v_cvt_pk_bf16_f32 v55, v46, v47
    s_add_u32 s66, s66, 4096
    buffer_store_dwordx4 v[48:51], v1, s[28:31], s66 offen offset:0 sc1
    buffer_store_dwordx4 v[52:55], v1, s[28:31], s66 offen offset:1024 sc1
    v_permlane16_swap_b32 v112, v116
    v_permlane16_swap_b32 v113, v117
    v_permlane16_swap_b32 v114, v118
    v_permlane16_swap_b32 v115, v119
    v_pk_mul_f32 v[40:41], v[112:113], v[112:113]
    v_pk_mul_f32 v[42:43], v[114:115], v[114:115]
    v_pk_fma_f32 v[40:41], v[40:41], v[28:29], v[28:29] op_sel:[0,1,0] op_sel_hi:[1,1,0]
    v_pk_fma_f32 v[42:43], v[42:43], v[28:29], v[28:29] op_sel:[0,1,0] op_sel_hi:[1,1,0]
    v_pk_mul_f32 v[40:41], v[112:113], v[40:41]
    v_pk_mul_f32 v[42:43], v[114:115], v[42:43]
    v_exp_f32_e64 v40, v40
    v_exp_f32_e64 v41, v41
    v_exp_f32_e64 v42, v42
    v_exp_f32_e64 v43, v43
    v_pk_fma_f32 v[40:41], v[40:41], v[30:31], v[30:31] op_sel:[0,0,0] op_sel_hi:[1,0,0]
    v_pk_fma_f32 v[42:43], v[42:43], v[30:31], v[30:31] op_sel:[0,0,0] op_sel_hi:[1,0,0]
    v_rcp_f32_e64 v40, v40
    v_rcp_f32_e64 v41, v41
    v_rcp_f32_e64 v42, v42
    v_rcp_f32_e64 v43, v43
    v_pk_mul_f32 v[40:41], v[112:113], v[40:41]
    v_pk_mul_f32 v[42:43], v[114:115], v[42:43]
    v_cvt_pk_bf16_f32 v32, v40, v41
    v_cvt_pk_bf16_f32 v33, v42, v43
    v_pk_mul_f32 v[44:45], v[116:117], v[116:117]
    v_pk_mul_f32 v[46:47], v[118:119], v[118:119]
    v_pk_fma_f32 v[44:45], v[44:45], v[28:29], v[28:29] op_sel:[0,1,0] op_sel_hi:[1,1,0]
    v_pk_fma_f32 v[46:47], v[46:47], v[28:29], v[28:29] op_sel:[0,1,0] op_sel_hi:[1,1,0]
    v_pk_mul_f32 v[44:45], v[116:117], v[44:45]
    v_pk_mul_f32 v[46:47], v[118:119], v[46:47]
    v_exp_f32_e64 v44, v44
    v_exp_f32_e64 v45, v45
    v_exp_f32_e64 v46, v46
    v_exp_f32_e64 v47, v47
    v_pk_fma_f32 v[44:45], v[44:45], v[30:31], v[30:31] op_sel:[0,0,0] op_sel_hi:[1,0,0]
    v_pk_fma_f32 v[46:47], v[46:47], v[30:31], v[30:31] op_sel:[0,0,0] op_sel_hi:[1,0,0]
    v_rcp_f32_e64 v44, v44
    v_rcp_f32_e64 v45, v45
    v_rcp_f32_e64 v46, v46
    v_rcp_f32_e64 v47, v47
    v_pk_mul_f32 v[44:45], v[116:117], v[44:45]
    v_pk_mul_f32 v[46:47], v[118:119], v[46:47]
    v_cvt_pk_bf16_f32 v34, v44, v45
    v_cvt_pk_bf16_f32 v35, v46, v47
    buffer_store_dwordx4 v[32:35], v1, s[28:31], s62 offen sc1
    s_waitcnt lgkmcnt(0)
    v_lshlrev_b32 v64, 16, v80
    v_and_b32 v65, 0xffff0000, v80
    v_lshlrev_b32 v66, 16, v81
    v_and_b32 v67, 0xffff0000, v81
    v_lshlrev_b32 v68, 16, v82
    v_and_b32 v69, 0xffff0000, v82
    v_lshlrev_b32 v70, 16, v83
    v_and_b32 v71, 0xffff0000, v83
    v_lshlrev_b32 v72, 16, v84
    v_and_b32 v73, 0xffff0000, v84
    v_lshlrev_b32 v74, 16, v85
    v_and_b32 v75, 0xffff0000, v85
    v_lshlrev_b32 v76, 16, v86
    v_and_b32 v77, 0xffff0000, v86
    v_lshlrev_b32 v78, 16, v87
    v_and_b32 v79, 0xffff0000, v87
    s_waitcnt vmcnt(22)
    s_nop 0
    v_mfma_f32_32x32x16_bf16 v[64:79], a[0:3], v[128:131], v[64:79]
    v_mfma_f32_32x32x16_bf16 v[80:95], a[4:7], v[128:131], 0
    buffer_load_dwordx4 v[176:179], v11, s[28:31], s5 offen offset:2048 sc1
    s_waitcnt vmcnt(12)
    ds_read_b64_tr_b16 a[32:33], v8 offset:0
    ds_read_b64_tr_b16 a[36:37], v9 offset:0
    ds_read_b64_tr_b16 a[34:35], v8 offset:1024
    ds_read_b64_tr_b16 a[38:39], v9 offset:1024
    v_mfma_f32_32x32x16_bf16 v[96:111], a[0:3], v[132:135], 0
    ds_read_b64_tr_b16 a[88:89], v8 offset:2048
    ds_read_b64_tr_b16 a[92:93], v9 offset:2048
    ds_read_b64_tr_b16 a[90:91], v8 offset:3072
    ds_read_b64_tr_b16 a[94:95], v9 offset:3072
    v_mfma_f32_32x32x16_bf16 v[112:127], a[4:7], v[132:135], 0
    buffer_load_dwordx4 v[180:183], v56, s[28:31], s5 offen offset:2048 sc1
    v_mfma_f32_32x32x16_bf16 v[64:79], a[8:11], v[136:139], v[64:79]
    s_waitcnt lgkmcnt(0)
    s_add_u32 m0, s64, 0
    s_lshl4_add_u32 s76, s79, 68608
    buffer_load_dwordx4 v7, s[20:23], s76 offen offset:0 lds
    v_mfma_f32_32x32x16_bf16 v[80:95], a[12:15], v[136:139], v[80:95]
    buffer_load_dwordx4 v[184:187], v11, s[28:31], s5 offen offset:3072 sc1
    buffer_load_dwordx4 v57, s[20:23], s76 offen offset:1024 lds
    v_mfma_f32_32x32x16_bf16 v[96:111], a[8:11], v[140:143], v[96:111]
    buffer_load_dwordx4 v58, s[20:23], s76 offen offset:2048 lds
    v_mfma_f32_32x32x16_bf16 v[112:127], a[12:15], v[140:143], v[112:127]
    buffer_load_dwordx4 v[188:191], v56, s[28:31], s5 offen offset:3072 sc1
    buffer_load_dwordx4 v59, s[20:23], s76 offen offset:3072 lds
    v_mfma_f32_32x32x16_bf16 v[64:79], a[16:19], v[144:147], v[64:79]
    v_mfma_f32_32x32x16_bf16 v[80:95], a[20:23], v[144:147], v[80:95]
    buffer_load_dwordx4 v[192:195], v11, s[28:31], s6 offen offset:0 sc1
    s_waitcnt vmcnt(12)
    ds_read_b64_tr_b16 a[152:153], v8 offset:4096
    ds_read_b64_tr_b16 a[156:157], v9 offset:4096
    ds_read_b64_tr_b16 a[154:155], v8 offset:5120
    ds_read_b64_tr_b16 a[158:159], v9 offset:5120
    v_mfma_f32_32x32x16_bf16 v[96:111], a[16:19], v[148:151], v[96:111]
    ds_read_b64_tr_b16 a[160:161], v8 offset:6144
    ds_read_b64_tr_b16 a[164:165], v9 offset:6144
    ds_read_b64_tr_b16 a[162:163], v8 offset:7168
    ds_read_b64_tr_b16 a[166:167], v9 offset:7168
    v_mfma_f32_32x32x16_bf16 v[112:127], a[20:23], v[148:151], v[112:127]
    buffer_load_dwordx4 v[196:199], v56, s[28:31], s6 offen offset:0 sc1
    v_mfma_f32_32x32x16_bf16 v[64:79], a[24:27], v[152:155], v[64:79]
    s_waitcnt lgkmcnt(0)
    s_add_u32 m0, s64, 4096
    s_add_u32 s76, s78, s80
    s_lshl4_add_u32 s76, s76, 3072
    buffer_load_dwordx4 v7, s[20:23], s76 offen offset:0 lds
    v_mfma_f32_32x32x16_bf16 v[80:95], a[28:31], v[152:155], v[80:95]
    buffer_load_dwordx4 v[200:203], v11, s[28:31], s6 offen offset:1024 sc1
    buffer_load_dwordx4 v57, s[20:23], s76 offen offset:1024 lds
    v_mfma_f32_32x32x16_bf16 v[96:111], a[24:27], v[156:159], v[96:111]
    s_add_u32 s76, s79, s81
    s_lshl4_add_u32 s76, s76, 4294953984
    buffer_load_dwordx4 v58, s[20:23], s76 offen offset:2048 lds
    v_mfma_f32_32x32x16_bf16 v[112:127], a[28:31], v[156:159], v[112:127]
    buffer_load_dwordx4 v[204:207], v56, s[28:31], s6 offen offset:1024 sc1
    buffer_load_dwordx4 v59, s[20:23], s76 offen offset:3072 lds
    v_mfma_f32_32x32x16_bf16 v[64:79], a[56:59], v[160:163], v[64:79]
    v_mfma_f32_32x32x16_bf16 v[80:95], a[60:63], v[160:163], v[80:95]
    buffer_load_dwordx4 v[208:211], v11, s[28:31], s6 offen offset:2048 sc1
    s_waitcnt vmcnt(9)
    ds_read_b64_tr_b16 a[208:209], v8 offset:0
    ds_read_b64_tr_b16 a[212:213], v9 offset:0
    ds_read_b64_tr_b16 a[210:211], v8 offset:1024
    ds_read_b64_tr_b16 a[214:215], v9 offset:1024
    v_mfma_f32_32x32x16_bf16 v[96:111], a[56:59], v[164:167], v[96:111]
    ds_read_b64_tr_b16 a[216:217], v8 offset:2048
    ds_read_b64_tr_b16 a[220:221], v9 offset:2048
    ds_read_b64_tr_b16 a[218:219], v8 offset:3072
    ds_read_b64_tr_b16 a[222:223], v9 offset:3072
    v_mfma_f32_32x32x16_bf16 v[112:127], a[60:63], v[164:167], v[112:127]
    buffer_load_dwordx4 v[212:215], v56, s[28:31], s6 offen offset:2048 sc1
    v_mfma_f32_32x32x16_bf16 v[64:79], a[64:67], v[168:171], v[64:79]
    s_cmp_lg_u32 s57, 0
    s_nop 10
    s_cbranch_scc1 Ls_42
    s_mov_b64 exec, 255
    buffer_store_dword v10, v6, s[28:31], s63 offen
    s_branch Ld_43
Ls_42:
    s_mov_b64 exec, 1
    buffer_store_dword v10, v6, s[28:31], s63 offen sc1
Ld_43:
    s_mov_b64 exec, -1
    s_add_u32 s63, s63, 512
    s_waitcnt lgkmcnt(0)
    v_mfma_f32_32x32x16_bf16 v[80:95], a[68:71], v[168:171], v[80:95]
    buffer_load_dwordx4 v[216:219], v11, s[28:31], s6 offen offset:3072 sc1
    v_mfma_f32_32x32x16_bf16 v[96:111], a[64:67], v[172:175], v[96:111]
    v_mfma_f32_32x32x16_bf16 v[112:127], a[68:71], v[172:175], v[112:127]
    buffer_load_dwordx4 v[220:223], v56, s[28:31], s6 offen offset:3072 sc1
    v_mfma_f32_32x32x16_bf16 v[64:79], a[72:75], v[176:179], v[64:79]
    v_mfma_f32_32x32x16_bf16 v[80:95], a[76:79], v[176:179], v[80:95]
    buffer_load_dwordx4 v[224:227], v11, s[28:31], s7 offen offset:0 sc1
    s_waitcnt vmcnt(6)
    ds_read_b64_tr_b16 a[144:145], v8 offset:4096
    ds_read_b64_tr_b16 a[148:149], v9 offset:4096
    ds_read_b64_tr_b16 a[146:147], v8 offset:5120
    ds_read_b64_tr_b16 a[150:151], v9 offset:5120
    v_mfma_f32_32x32x16_bf16 v[96:111], a[72:75], v[180:183], v[96:111]
    ds_read_b64_tr_b16 a[200:201], v8 offset:6144
    ds_read_b64_tr_b16 a[204:205], v9 offset:6144
    ds_read_b64_tr_b16 a[202:203], v8 offset:7168
    ds_read_b64_tr_b16 a[206:207], v9 offset:7168
    v_mfma_f32_32x32x16_bf16 v[112:127], a[76:79], v[180:183], v[112:127]
    buffer_load_dwordx4 v[228:231], v56, s[28:31], s7 offen offset:0 sc1
    v_mfma_f32_32x32x16_bf16 v[64:79], a[80:83], v[184:187], v[64:79]
    s_waitcnt lgkmcnt(0)
    v_mfma_f32_32x32x16_bf16 v[80:95], a[84:87], v[184:187], v[80:95]
    buffer_load_dwordx4 v[232:235], v11, s[28:31], s7 offen offset:1024 sc1
    v_mfma_f32_32x32x16_bf16 v[96:111], a[80:83], v[188:191], v[96:111]
    v_mfma_f32_32x32x16_bf16 v[112:127], a[84:87], v[188:191], v[112:127]
    buffer_load_dwordx4 v[236:239], v56, s[28:31], s7 offen offset:1024 sc1
    v_mfma_f32_32x32x16_bf16 v[64:79], a[112:115], v[192:195], v[64:79]
    v_mfma_f32_32x32x16_bf16 v[80:95], a[116:119], v[192:195], v[80:95]
    buffer_load_dwordx4 v[240:243], v11, s[28:31], s7 offen offset:2048 sc1
    v_mfma_f32_32x32x16_bf16 v[96:111], a[112:115], v[196:199], v[96:111]
    v_mfma_f32_32x32x16_bf16 v[112:127], a[116:119], v[196:199], v[112:127]
    buffer_load_dwordx4 v[244:247], v56, s[28:31], s7 offen offset:2048 sc1
    v_mfma_f32_32x32x16_bf16 v[64:79], a[120:123], v[200:203], v[64:79]
    v_mfma_f32_32x32x16_bf16 v[80:95], a[124:127], v[200:203], v[80:95]
    buffer_load_dwordx4 v[248:251], v11, s[28:31], s7 offen offset:3072 sc1
    v_mfma_f32_32x32x16_bf16 v[96:111], a[120:123], v[204:207], v[96:111]
    v_mfma_f32_32x32x16_bf16 v[112:127], a[124:127], v[204:207], v[112:127]
    buffer_load_dwordx4 v[252:255], v56, s[28:31], s7 offen offset:3072 sc1
    s_mov_b32 s71, s57
    s_mov_b32 s72, 0
    s_cmp_ge_u32 s71, 512
    s_nop 7
    s_cbranch_scc1 Lg_48
    s_add_u32 s70, s67, s71
    s_load_dwordx8 s[36:43], s[60:61], s70
    s_add_u32 s71, s71, 64
    s_branch Lb_47
Lg_48:
    s_load_dwordx8 s[36:43], s[60:61], s67 glc
Lb_47:
    s_waitcnt vmcnt(12)
    v_mfma_f32_32x32x16_bf16 v[64:79], a[128:131], v[208:211], v[64:79]
    v_mfma_f32_32x32x16_bf16 v[80:95], a[132:135], v[208:211], v[80:95]
    s_waitcnt vmcnt(11)
    v_mfma_f32_32x32x16_bf16 v[96:111], a[128:131], v[212:215], v[96:111]
    v_mfma_f32_32x32x16_bf16 v[112:127], a[132:135], v[212:215], v[112:127]
    s_waitcnt vmcnt(9)
    v_mfma_f32_32x32x16_bf16 v[64:79], a[136:139], v[216:219], v[64:79]
    v_mfma_f32_32x32x16_bf16 v[80:95], a[140:143], v[216:219], v[80:95]
    s_waitcnt vmcnt(8)
    v_mfma_f32_32x32x16_bf16 v[96:111], a[136:139], v[220:223], v[96:111]
    v_mfma_f32_32x32x16_bf16 v[112:127], a[140:143], v[220:223], v[112:127]
    s_nop 11
    s_branch Lw_45
Lp_44:
    s_add_u32 s72, s72, 1
    s_cmp_gt_u32 s72, 30000
    s_cbranch_scc1 L_end
    s_cmp_ge_u32 s71, 512
    s_cbranch_scc1 Lg_49
    s_add_u32 s70, s67, s71
    s_load_dwordx8 s[36:43], s[60:61], s70
    s_add_u32 s71, s71, 64
    s_branch Lw_45
Lg_49:
    s_load_dwordx8 s[36:43], s[60:61], s67 glc
Lw_45:
    s_waitcnt lgkmcnt(0)
    s_and_b64 s[36:37], s[36:37], s[40:41]
    s_and_b64 s[38:39], s[38:39], s[42:43]
    s_and_b64 s[36:37], s[36:37], s[38:39]
    s_and_b32 s36, s36, s37
    s_cbranch_scc0 Lp_44
    s_add_u32 s69, s4, 4096
    buffer_load_dwordx4 v[128:131], v11, s[28:31], s69 offen offset:0 sc1
    buffer_load_dwordx4 v[132:135], v56, s[28:31], s69 offen offset:0 sc1
    buffer_load_dwordx4 v[136:139], v11, s[28:31], s69 offen offset:1024 sc1
    buffer_load_dwordx4 v[140:143], v56, s[28:31], s69 offen offset:1024 sc1
    s_waitcnt vmcnt(11)
    v_mfma_f32_32x32x16_bf16 v[64:79], a[168:171], v[224:227], v[64:79]
    v_mfma_f32_32x32x16_bf16 v[80:95], a[172:175], v[224:227], v[80:95]
    s_add_u32 s69, s5, 4096
    buffer_load_dwordx4 v[144:147], v11, s[28:31], s69 offen offset:0 sc1
    s_waitcnt vmcnt(11)
    v_mfma_f32_32x32x16_bf16 v[96:111], a[168:171], v[228:231], v[96:111]
    v_mfma_f32_32x32x16_bf16 v[112:127], a[172:175], v[228:231], v[112:127]
    buffer_load_dwordx4 v[148:151], v56, s[28:31], s69 offen offset:0 sc1
    s_waitcnt vmcnt(11)
    v_mfma_f32_32x32x16_bf16 v[64:79], a[176:179], v[232:235], v[64:79]
    v_mfma_f32_32x32x16_bf16 v[80:95], a[180:183], v[232:235], v[80:95]
    buffer_load_dwordx4 v[152:155], v11, s[28:31], s69 offen offset:1024 sc1
    s_waitcnt vmcnt(11)
    v_mfma_f32_32x32x16_bf16 v[96:111], a[176:179], v[236:239], v[96:111]
    v_mfma_f32_32x32x16_bf16 v[112:127], a[180:183], v[236:239], v[112:127]
    buffer_load_dwordx4 v[156:159], v56, s[28:31], s69 offen offset:1024 sc1
    s_waitcnt vmcnt(11)
    v_mfma_f32_32x32x16_bf16 v[64:79], a[184:187], v[240:243], v[64:79]
    v_mfma_f32_32x32x16_bf16 v[80:95], a[188:191], v[240:243], v[80:95]
    s_add_u32 s69, s4, s80
    buffer_load_dwordx4 v[160:163], v11, s[28:31], s69 offen offset:0 sc1
    s_waitcnt vmcnt(11)
    v_mfma_f32_32x32x16_bf16 v[96:111], a[184:187], v[244:247], v[96:111]
    v_mfma_f32_32x32x16_bf16 v[112:127], a[188:191], v[244:247], v[112:127]
    buffer_load_dwordx4 v[164:167], v56, s[28:31], s69 offen offset:0 sc1
    s_waitcnt vmcnt(11)
    v_mfma_f32_32x32x16_bf16 v[64:79], a[192:195], v[248:251], v[64:79]
    v_mfma_f32_32x32x16_bf16 v[80:95], a[196:199], v[248:251], v[80:95]
    s_add_u32 s69, s5, s81
    buffer_load_dwordx4 v[168:171], v11, s[28:31], s69 offen offset:0 sc1
    s_waitcnt vmcnt(11)
    v_mfma_f32_32x32x16_bf16 v[96:111], a[192:195], v[252:255], v[96:111]
    v_mfma_f32_32x32x16_bf16 v[112:127], a[196:199], v[252:255], v[112:127]
    buffer_load_dwordx4 v[172:175], v56, s[28:31], s69 offen offset:0 sc1
    s_waitcnt vmcnt(11)
    v_mfma_f32_32x32x16_bf16 v[64:79], a[40:43], v[128:131], v[64:79]
    v_mfma_f32_32x32x16_bf16 v[80:95], a[44:47], v[128:131], v[80:95]
    s_add_u32 s69, s6, 4096
    buffer_load_dwordx4 v[176:179], v11, s[28:31], s69 offen offset:0 sc1
    s_waitcnt vmcnt(11)
    v_mfma_f32_32x32x16_bf16 v[96:111], a[40:43], v[132:135], v[96:111]
    v_mfma_f32_32x32x16_bf16 v[112:127], a[44:47], v[132:135], v[112:127]
    buffer_load_dwordx4 v[180:183], v56, s[28:31], s69 offen offset:0 sc1
    s_waitcnt vmcnt(11)
    v_mfma_f32_32x32x16_bf16 v[64:79], a[48:51], v[136:139], v[64:79]
    v_mfma_f32_32x32x16_bf16 v[80:95], a[52:55], v[136:139], v[80:95]
    buffer_load_dwordx4 v[184:187], v11, s[28:31], s69 offen offset:1024 sc1
    s_waitcnt vmcnt(11)
    v_mfma_f32_32x32x16_bf16 v[96:111], a[48:51], v[140:143], v[96:111]
    v_mfma_f32_32x32x16_bf16 v[112:127], a[52:55], v[140:143], v[112:127]
    buffer_load_dwordx4 v[188:191], v56, s[28:31], s69 offen offset:1024 sc1
    s_waitcnt vmcnt(11)
    v_mfma_f32_32x32x16_bf16 v[64:79], a[96:99], v[144:147], v[64:79]
    v_mfma_f32_32x32x16_bf16 v[80:95], a[100:103], v[144:147], v[80:95]
    s_add_u32 s69, s7, 4096
    buffer_load_dwordx4 v[192:195], v11, s[28:31], s69 offen offset:0 sc1
    s_waitcnt vmcnt(11)
    v_mfma_f32_32x32x16_bf16 v[96:111], a[96:99], v[148:151], v[96:111]
    v_mfma_f32_32x32x16_bf16 v[112:127], a[100:103], v[148:151], v[112:127]
    buffer_load_dwordx4 v[196:199], v56, s[28:31], s69 offen offset:0 sc1
    s_waitcnt vmcnt(11)
    v_mfma_f32_32x32x16_bf16 v[64:79], a[104:107], v[152:155], v[64:79]
    v_mfma_f32_32x32x16_bf16 v[80:95], a[108:111], v[152:155], v[80:95]
    buffer_load_dwordx4 v[200:203], v11, s[28:31], s69 offen offset:1024 sc1
    s_waitcnt vmcnt(11)
    v_mfma_f32_32x32x16_bf16 v[96:111], a[104:107], v[156:159], v[96:111]
    v_mfma_f32_32x32x16_bf16 v[112:127], a[108:111], v[156:159], v[112:127]
    buffer_load_dwordx4 v[204:207], v56, s[28:31], s69 offen offset:1024 sc1
    s_waitcnt vmcnt(11)
    v_mfma_f32_32x32x16_bf16 v[64:79], a[32:35], v[160:163], v[64:79]
    v_mfma_f32_32x32x16_bf16 v[80:95], a[36:39], v[160:163], v[80:95]
    s_add_u32 s69, s6, s80
    buffer_load_dwordx4 v[208:211], v11, s[28:31], s69 offen offset:0 sc1
    s_waitcnt vmcnt(11)
    v_mfma_f32_32x32x16_bf16 v[96:111], a[32:35], v[164:167], v[96:111]
    v_mfma_f32_32x32x16_bf16 v[112:127], a[36:39], v[164:167], v[112:127]
    buffer_load_dwordx4 v[212:215], v56, s[28:31], s69 offen offset:0 sc1
    s_waitcnt vmcnt(11)
    v_mfma_f32_32x32x16_bf16 v[64:79], a[88:91], v[168:171], v[64:79]
    v_mfma_f32_32x32x16_bf16 v[80:95], a[92:95], v[168:171], v[80:95]
    s_add_u32 s69, s7, s81
    buffer_load_dwordx4 v[216:219], v11, s[28:31], s69 offen offset:0 sc1
    s_waitcnt vmcnt(11)
    v_mfma_f32_32x32x16_bf16 v[96:111], a[88:91], v[172:175], v[96:111]
    v_mfma_f32_32x32x16_bf16 v[112:127], a[92:95], v[172:175], v[112:127]
    buffer_load_dwordx4 v[220:223], v56, s[28:31], s69 offen offset:0 sc1
    s_waitcnt vmcnt(11)
    v_mfma_f32_32x32x16_bf16 v[64:79], a[152:155], v[176:179], v[64:79]
    v_mfma_f32_32x32x16_bf16 v[80:95], a[156:159], v[176:179], v[80:95]
    s_waitcnt vmcnt(10)
    v_mfma_f32_32x32x16_bf16 v[96:111], a[152:155], v[180:183], v[96:111]
    v_mfma_f32_32x32x16_bf16 v[112:127], a[156:159], v[180:183], v[112:127]
    s_waitcnt vmcnt(9)
    v_mfma_f32_32x32x16_bf16 v[64:79], a[160:163], v[184:187], v[64:79]
    s_barrier
    s_lshl_b32 s68, s3, 14
    v_mfma_f32_32x32x16_bf16 v[80:95], a[164:167], v[184:187], v[80:95]
    v_add_u32 v40, s68, v1
    v_xor_b32 v41, 16384, v40
    s_waitcnt vmcnt(8)
    v_mfma_f32_32x32x16_bf16 v[96:111], a[160:163], v[188:191], v[96:111]
    v_xor_b32 v42, 32768, v40
    v_xor_b32 v43, 49152, v40
    v_mfma_f32_32x32x16_bf16 v[112:127], a[164:167], v[188:191], v[112:127]
    s_lshr_b32 s65, s3, 1
    s_lshl_b32 s65, s65, 15
    s_waitcnt vmcnt(7)
    v_mfma_f32_32x32x16_bf16 v[64:79], a[208:211], v[192:195], v[64:79]
    s_and_b32 s68, s3, 1
    s_lshl_b32 s68, s68, 6
    v_mfma_f32_32x32x16_bf16 v[80:95], a[212:215], v[192:195], v[80:95]
    s_add_u32 s65, s65, s68
    v_and_b32 v44, 31, v0
    s_waitcnt vmcnt(6)
    v_mfma_f32_32x32x16_bf16 v[96:111], a[208:211], v[196:199], v[96:111]
    v_lshrrev_b32 v45, 5, v0
    v_bfe_u32 v46, v0, 1, 2
    v_mfma_f32_32x32x16_bf16 v[112:127], a[212:215], v[196:199], v[112:127]
    v_lshlrev_b32 v44, 6, v44
    v_lshl_add_u32 v44, v45, 3, v44
    s_waitcnt vmcnt(5)
    v_mfma_f32_32x32x16_bf16 v[64:79], a[216:219], v[200:203], v[64:79]
    v_lshl_add_u32 v44, v46, 4, v44
    s_lshl_b32 s68, s3, 14
    v_mfma_f32_32x32x16_bf16 v[80:95], a[220:223], v[200:203], v[80:95]
    v_add_u32 v32, s68, v44
    v_xor_b32 v33, 16, v32
    s_waitcnt vmcnt(4)
    v_mfma_f32_32x32x16_bf16 v[96:111], a[216:219], v[204:207], v[96:111]
    v_xor_b32 v34, 32, v32
    v_xor_b32 v35, 48, v32
    v_mfma_f32_32x32x16_bf16 v[112:127], a[220:223], v[204:207], v[112:127]
    v_bfe_u32 v45, v0, 3, 2
    v_lshlrev_b32 v45, 4, v45
    s_waitcnt vmcnt(3)
    v_mfma_f32_32x32x16_bf16 v[64:79], a[144:147], v[208:211], v[64:79]
    v_xor_b32 v36, v45, v40
    v_lshrrev_b32 v44, 2, v0
    v_mfma_f32_32x32x16_bf16 v[80:95], a[148:151], v[208:211], v[80:95]
    v_and_b32 v45, 3, v0
    v_lshlrev_b32 v44, 10, v44
    s_waitcnt vmcnt(2)
    v_mfma_f32_32x32x16_bf16 v[96:111], a[144:147], v[212:215], v[96:111]
    v_lshl_add_u32 v44, v45, 4, v44
    s_add_u32 s68, s65, 16384
    v_mfma_f32_32x32x16_bf16 v[112:127], a[148:151], v[212:215], v[112:127]
    s_waitcnt vmcnt(1)
    v_mfma_f32_32x32x16_bf16 v[64:79], a[200:203], v[216:219], v[64:79]
    v_mfma_f32_32x32x16_bf16 v[80:95], a[204:207], v[216:219], v[80:95]
    s_waitcnt vmcnt(0)
    v_mfma_f32_32x32x16_bf16 v[96:111], a[200:203], v[220:223], v[96:111]
    v_mfma_f32_32x32x16_bf16 v[112:127], a[204:207], v[220:223], v[112:127]
    s_nop 8
    ds_write_b128 v41, v[80:83] offset:4096
    ds_write_b128 v41, v[84:87] offset:5120
    ds_write_b128 v41, v[88:91] offset:6144
    ds_write_b128 v41, v[92:95] offset:7168
    ds_write_b128 v42, v[96:99] offset:8192
    ds_write_b128 v42, v[100:103] offset:9216
    ds_write_b128 v42, v[104:107] offset:10240
    ds_write_b128 v42, v[108:111] offset:11264
    ds_write_b128 v43, v[112:115] offset:12288
    ds_write_b128 v43, v[116:119] offset:13312
    ds_write_b128 v43, v[120:123] offset:14336
    ds_write_b128 v43, v[124:127] offset:15360
    s_waitcnt lgkmcnt(0)
    s_barrier
    ds_read_b128 v[144:147], v40 offset:4096
    ds_read_b128 v[160:163], v40 offset:8192
    ds_read_b128 v[176:179], v40 offset:12288
    ds_read_b128 v[148:151], v40 offset:5120
    ds_read_b128 v[164:167], v40 offset:9216
    ds_read_b128 v[180:183], v40 offset:13312
    ds_read_b128 v[152:155], v40 offset:6144
    ds_read_b128 v[168:171], v40 offset:10240
    ds_read_b128 v[184:187], v40 offset:14336
    ds_read_b128 v[156:159], v40 offset:7168
    ds_read_b128 v[172:175], v40 offset:11264
    ds_read_b128 v[188:191], v40 offset:15360
    s_waitcnt lgkmcnt(9)
    v_pk_add_f32 v[64:65], v[64:65], v[144:145]
    v_pk_add_f32 v[160:161], v[160:161], v[176:177]
    v_pk_add_f32 v[66:67], v[66:67], v[146:147]
    v_pk_add_f32 v[162:163], v[162:163], v[178:179]
    v_pk_add_f32 v[64:65], v[64:65], v[160:161]
    v_pk_add_f32 v[66:67], v[66:67], v[162:163]
    v_cvt_pk_bf16_f32 v48, v64, v65
    v_cvt_pk_bf16_f32 v49, v66, v67
    ds_write_b64 v32, v[48:49] offset:0
    s_waitcnt lgkmcnt(7)
    v_pk_add_f32 v[68:69], v[68:69], v[148:149]
    v_pk_add_f32 v[164:165], v[164:165], v[180:181]
    v_pk_add_f32 v[70:71], v[70:71], v[150:151]
    v_pk_add_f32 v[166:167], v[166:167], v[182:183]
    v_pk_add_f32 v[68:69], v[68:69], v[164:165]
    v_pk_add_f32 v[70:71], v[70:71], v[166:167]
    v_cvt_pk_bf16_f32 v50, v68, v69
    v_cvt_pk_bf16_f32 v51, v70, v71
    ds_write_b64 v33, v[50:51] offset:0
    s_waitcnt lgkmcnt(5)
    v_pk_add_f32 v[72:73], v[72:73], v[152:153]
    v_pk_add_f32 v[168:169], v[168:169], v[184:185]
    v_pk_add_f32 v[74:75], v[74:75], v[154:155]
    v_pk_add_f32 v[170:171], v[170:171], v[186:187]
    v_pk_add_f32 v[72:73], v[72:73], v[168:169]
    v_pk_add_f32 v[74:75], v[74:75], v[170:171]
    v_cvt_pk_bf16_f32 v52, v72, v73
    v_cvt_pk_bf16_f32 v53, v74, v75
    ds_write_b64 v34, v[52:53] offset:0
    s_waitcnt lgkmcnt(3)
    v_pk_add_f32 v[76:77], v[76:77], v[156:157]
    v_pk_add_f32 v[172:173], v[172:173], v[188:189]
    v_pk_add_f32 v[78:79], v[78:79], v[158:159]
    v_pk_add_f32 v[174:175], v[174:175], v[190:191]
    v_pk_add_f32 v[76:77], v[76:77], v[172:173]
    v_pk_add_f32 v[78:79], v[78:79], v[174:175]
    v_cvt_pk_bf16_f32 v54, v76, v77
    v_cvt_pk_bf16_f32 v55, v78, v79
    ds_write_b64 v35, v[54:55] offset:0
    ds_read_b128 v[128:131], v36 offset:0
    ds_read_b128 v[132:135], v36 offset:1024
    s_waitcnt lgkmcnt(1)
    buffer_store_dwordx4 v[128:131], v44, s[24:27], s65 offen sc1
    s_waitcnt lgkmcnt(0)
    buffer_store_dwordx4 v[132:135], v44, s[24:27], s68 offen sc1
    s_nop 1
L_end:
    s_endpgm
L_codeend:
.section .rodata,"a"
.p2align 6
.amdhsa_kernel standalone__mixer_s_mlp__prompt_kernel
  .amdhsa_next_free_vgpr 512
  .amdhsa_next_free_sgpr 102
  .amdhsa_accum_offset 256
  .amdhsa_group_segment_fixed_size 0
  .amdhsa_kernarg_size 64
  .amdhsa_user_sgpr_count 2
  .amdhsa_user_sgpr_kernarg_segment_ptr 1
  .amdhsa_system_sgpr_workgroup_id_x 1
.end_amdhsa_kernel
```
